```python
import torch

def _softmax(x, axis=-1):
    return torch.softmax(x, dim=axis)
def _gelu(x):
    return torch.nn.functional.gelu(x, approximate="tanh")
def _silu(x):
    return torch.nn.functional.silu(x)
def _sigmoid(x):
    return torch.sigmoid(x)
def _layernorm(x, axis=-1, eps=1e-5):
    m = x.mean(dim=axis, keepdim=True)
    v = x.var(dim=axis, keepdim=True, unbiased=False)
    return (x - m) / torch.sqrt(v + eps)
def _scatter_add(tgt, idx, src, axis=0):
    return tgt.clone().index_add_(axis, idx, src)
def _segment_sum(src, seg, n):
    out = torch.zeros((n,) + src.shape[1:], dtype=src.dtype)
    return out.index_add_(0, seg, src)
def _pad(x, pw):
    flat = tuple(v for pair in reversed(pw) for v in pair)
    return torch.nn.functional.pad(x, flat)

kernel_name = 'sequential_preLN__gqa_block_cached__mixer_token_mlp__decode'

def setup_inputs():

    _w = (lambda a: (lambda t: t.to(torch.bfloat16) if t.is_floating_point() else t)(torch.as_tensor(a)))
    def _A_setup():
        B, Sq, D = 2, 1, 1024
        Hq, Hkv, Sk, Dh = 32, 4, 32768, 128
        assert Hq % Hkv == 0, (Hq, Hkv)
        return {
            "x": _w((lambda *s: torch.randn(*s, dtype=torch.bfloat16) * 0.05)(B, Sq, D)),
            "k_cache": _w((lambda *s: torch.randn(*s, dtype=torch.bfloat16) * 3.2)(B, Hkv, Sk, Dh)),
            "v_cache": _w((lambda *s: torch.randn(*s, dtype=torch.bfloat16) * 0.8)(B, Hkv, Sk, Dh)),
            "wq": _w((lambda *s: torch.randn(*s, dtype=torch.bfloat16) * 3.2)(D, Hq * Dh) * (D ** -0.5)),
            "wo": _w((lambda *s: torch.randn(*s, dtype=torch.bfloat16) * 0.8)(Hq * Dh, D) * ((Hq * Dh) ** -0.5)),
        }
    _A_in = _A_setup()

    def _B_setup():
        B, S, D, F = 2, 1, 1024, 3584
        return {
            "x": _w((lambda *s: torch.randn(*s, dtype=torch.bfloat16) * 0.05)(B, S, D)),
            "w1": _w((lambda *s: torch.randn(*s, dtype=torch.bfloat16) * 1.6)(S, F) * (S ** -0.5)),
            "b1": _w((lambda *s: torch.randn(*s, dtype=torch.bfloat16) * 1.6)(F) * 0.02),
            "w2": _w((lambda *s: torch.randn(*s, dtype=torch.bfloat16) * 1.6)(F, S) * (F ** -0.5)),
            "b2": _w((lambda *s: torch.randn(*s, dtype=torch.bfloat16) * 0.8)(S) * 0.02),
        }
    _B_in = _B_setup()

    return {
        "A_x": _A_in["x"],
        "A_k_cache": _A_in["k_cache"],
        "A_v_cache": _A_in["v_cache"],
        "A_wq": _A_in["wq"],
        "A_wo": _A_in["wo"],
        "B_x": _B_in["x"],
        "B_w1": _B_in["w1"],
        "B_b1": _B_in["b1"],
        "B_w2": _B_in["w2"],
        "B_b2": _B_in["b2"],
    }

def reference(A_x, A_k_cache, A_v_cache, A_wq, A_wo, B_x, B_w1, B_b1, B_w2, B_b2):
    def _A_ref(x, k_cache, v_cache, wq, wo):
        B, Sq, D = x.shape
        Hq, Dh = 32, 128
        Hkv = k_cache.shape[1]
        rep = Hq // Hkv
        q = (lambda x, *d: x.permute(*d))((x @ wq).reshape(B, Sq, Hq, Dh), 0, 2, 1, 3)
        k = (lambda x, n, axis: torch.repeat_interleave(x, n, dim=axis))(k_cache, rep, axis=1)
        v = (lambda x, n, axis: torch.repeat_interleave(x, n, dim=axis))(v_cache, rep, axis=1)
        scores = torch.einsum("bhqd,bhkd->bhqk", q, k) * (Dh ** -0.5)
        p = _softmax(scores, axis=-1)
        o = torch.einsum("bhqk,bhkd->bhqd", p, v)
        return (lambda x, *d: x.permute(*d))(o, 0, 2, 1, 3).reshape(B, Sq, Hq * Dh) @ wo

    def _B_ref(x, w1, b1, w2, b2):
        B, S, D = x.shape
        h = _layernorm(x, axis=-1)
        u = torch.einsum("bsd,sf->bdf", h, w1) + b1
        u = _gelu(u)
        y = torch.einsum("bdf,fs->bds", u, w2) + b2
        return (lambda x, *d: x.permute(*d))(y, 0, 2, 1)

    x = A_x
    h = x + _A_ref(_layernorm(x, axis=-1), A_k_cache, A_v_cache, A_wq, A_wo)
    h2 = h + _B_ref(_layernorm(h, axis=-1), B_w1, B_b1, B_w2, B_b2)
    return h2
```

```asm
; @launch grid=(256,1,1) block=(512,1,1) lds=41984
.amdgcn_target "amdgcn-amd-amdhsa--gfx950"
.text
.globl sequential_preLN__gqa_block_cached__mixer_token_mlp__decode_kernel
.p2align 8
.type sequential_preLN__gqa_block_cached__mixer_token_mlp__decode_kernel,@function
sequential_preLN__gqa_block_cached__mixer_token_mlp__decode_kernel:
    s_load_dwordx16 s[4:19], s[0:1], 0
    s_load_dwordx8 s[20:27], s[0:1], 64
    s_load_dwordx2 s[28:29], s[0:1], 96
    s_cmp_ge_u32 s2, 256
    s_cbranch_scc1 L_end
    v_lshrrev_b32 v4, 6, v0
    v_and_b32 v1, 63, v0
    v_readfirstlane_b32 s3, v4
    v_and_b32 v5, 3, v1
    v_lshlrev_b32 v5, 2, v5
    v_bfe_u32 v6, v1, 2, 2
    v_add_u32 v5, v5, v6
    v_lshlrev_b32 v2, 8, v5
    v_and_b32 v6, 0x30, v1
    v_or_b32 v2, v2, v6
    v_and_b32 v5, 3, v1
    v_lshlrev_b32 v5, 2, v5
    v_bfe_u32 v6, v1, 2, 1
    v_add_u32 v5, v5, v6
    v_lshlrev_b32 v2, 8, v5
    v_and_b32 v6, 0x30, v1
    v_or_b32 v2, v2, v6
    v_and_b32 v6, 8, v1
    v_lshl_or_b32 v2, v6, 3, v2
    v_lshlrev_b32 v3, 4, v1
    s_and_b32 s30, s2, 7
    s_lshr_b32 s79, s2, 3
    s_lshr_b32 s77, s30, 2
    s_and_b32 s78, s30, 3
    s_lshl_b32 s31, s30, 23
    s_lshl_b32 s82, s79, 18
    s_add_u32 s31, s31, s82
    s_lshl_b32 s82, s3, 15
    s_add_u32 s31, s31, s82
    s_lshl_b32 s88, s30, 5
    s_add_u32 s88, s88, s79
    s_mov_b32 s80, 0
    s_mov_b32 s81, 0
    v_lshlrev_b32 v7, 5, v1
    v_lshrrev_b32 v60, 3, v1
    v_lshlrev_b32 v61, 3, v60
    s_lshr_b32 s82, s88, 6
    s_lshl_b32 s82, s82, 3
    s_add_u32 s82, s82, s3
    s_lshl_b32 s46, s82, 18
    s_lshl_b32 s82, s82, 6
    v_add_u32 v61, s82, v61
    v_lshlrev_b32 v62, 15, v60
    v_and_b32 v63, 7, v1
    v_lshlrev_b32 v63, 4, v63
    v_or_b32 v62, v62, v63
    s_waitcnt lgkmcnt(0)
    s_load_dword s76, s[28:29], 0
    s_add_u32 s36, s6, s31
    s_addc_u32 s37, s7, 0
    s_mov_b32 s38, 32768
    s_mov_b32 s39, 0x00020000
    s_mov_b32 s32, s4
    s_mov_b32 s33, s5
    s_mov_b32 s34, 4096
    s_mov_b32 s35, 0x00020000
    s_and_b32 s82, s88, 63
    s_lshl_b32 s82, s82, 7
    s_add_u32 s82, s82, s46
    s_add_u32 s44, s10, s82
    s_addc_u32 s45, s11, 0
    s_mov_b32 s46, 254080
    s_mov_b32 s47, 0x00020000
    buffer_load_dwordx4 v[8:11], v7, s[32:35], 0 offen
    buffer_load_dwordx4 v[12:15], v7, s[32:35], 0 offen offset:16
    buffer_load_dwordx4 v[16:19], v7, s[32:35], 0 offen offset:2048
    buffer_load_dwordx4 v[20:23], v7, s[32:35], 0 offen offset:2064
    buffer_load_dwordx2 v[24:25], v61, s[32:35], 0 offen
    buffer_load_dwordx2 v[26:27], v61, s[32:35], 0 offen offset:2048
    buffer_load_dwordx4 v[28:31], v62, s[44:47], 0 offen nt
    s_mov_b32 s82, 8192
    buffer_load_dwordx4 v[32:35], v62, s[44:47], s82 offen nt
    s_mov_b32 s82, 16384
    buffer_load_dwordx4 v[36:39], v62, s[44:47], s82 offen nt
    s_mov_b32 s82, 24576
    buffer_load_dwordx4 v[40:43], v62, s[44:47], s82 offen nt
    buffer_load_dwordx4 v[128:131], v2, s[36:39], s80 offen offset:0 nt
    v_xor_b32 v63, 64, v2
    v_add_u32 v63, 0x200, v63
    buffer_load_dwordx4 v[132:135], v63, s[36:39], s80 offen offset:0 nt
    s_add_u32 s40, s8, s31
    s_addc_u32 s41, s9, 0
    s_mov_b32 s42, 32768
    s_mov_b32 s43, 0x00020000
    s_and_b32 s82, s2, 3
    s_bfe_u32 s83, s2, 0x10003
    s_lshl_b32 s83, 1, s83
    s_xor_b32 s83, s83, s82
    s_lshl_b32 s30, s83, 5
    s_bfe_u32 s83, s2, 0x10002
    s_add_u32 s30, s30, s83
    s_lshr_b32 s83, s2, 4
    s_lshl_b32 s83, s83, 1
    s_add_u32 s30, s30, s83
    s_lshr_b32 s31, s82, 1
    s_lshl_b32 s82, s30, 16
    s_lshl_b32 s83, s31, 10
    s_add_u32 s82, s82, s83
    s_lshl_b32 s83, s3, 7
    s_add_u32 s82, s82, s83
    s_add_u32 s48, s12, s82
    s_addc_u32 s49, s13, 0
    s_mov_b32 s50, 63616
    s_mov_b32 s51, 0x00020000
    s_mov_b32 s52, s16
    s_mov_b32 s53, s17
    s_mov_b32 s54, 7168
    s_mov_b32 s55, 0x00020000
    s_mov_b32 s56, s18
    s_mov_b32 s57, s19
    s_mov_b32 s58, 7168
    s_mov_b32 s59, 0x00020000
    s_mov_b32 s60, s20
    s_mov_b32 s61, s21
    s_mov_b32 s62, 7168
    s_mov_b32 s63, 0x00020000
    s_mov_b32 s64, s28
    s_mov_b32 s65, s29
    s_mov_b32 s66, 16777216
    s_mov_b32 s67, 0x00020000
    s_mov_b32 s68, s24
    s_mov_b32 s69, s25
    s_mov_b32 s70, 4096
    s_mov_b32 s71, 0x00020000
    s_mov_b32 s72, s22
    s_mov_b32 s73, s23
    s_mov_b32 s74, 2
    s_mov_b32 s75, 0x00020000
    s_mov_b32 s89, 0x05040100
    s_mov_b32 s90, 0x07060302
    s_mov_b32 s91, 0xfffffc00
    s_mov_b32 s92, 0xffff0000
    s_mov_b32 s94, 0x3fb8aa3b
    s_lshl_b32 s95, s77, 14
    s_lshl_b32 s82, s78, 12
    s_add_u32 s95, s95, s82
    s_lshl_b32 s82, s3, 9
    s_add_u32 s95, s95, s82
    s_add_u32 s95, s95, 4096
    s_mul_i32 s96, s78, 262144
    s_lshl_b32 s82, s77, 12
    s_add_u32 s96, s96, s82
    s_lshl_b32 s82, s79, 7
    s_add_u32 s96, s96, s82
    s_add_u32 s96, s96, 1048576
    s_lshl_b32 s78, s78, 13
    s_lshl_b32 s82, s77, 9
    s_add_u32 s78, s78, s82
    s_lshl_b32 s82, s79, 4
    s_add_u32 s78, s78, s82
    s_add_u32 s78, s78, 6291456
    s_and_b32 s83, s3, 1
    s_mul_i32 s97, s30, 8192
    s_lshl_b32 s82, s83, 12
    s_add_u32 s97, s97, s82
    s_add_u32 s97, s97, 1048576
    s_lshr_b32 s79, s30, 2
    s_lshl_b32 s79, s79, 10
    s_lshl_b32 s82, s83, 9
    s_add_u32 s79, s79, s82
    s_add_u32 s79, s79, 6291456
    s_mul_i32 s99, s2, 8192
    s_add_u32 s99, s99, 4194304
    s_lshl_b32 s82, s3, 4
    s_sub_u32 s83, 1, s31
    s_lshl_b32 s83, s83, 1
    s_add_u32 s82, s82, s83
    s_mul_i32 s98, s82, 8192
    s_lshl_b32 s82, s30, 5
    s_add_u32 s98, s98, s82
    s_add_u32 s98, s98, 4194304
    s_lshr_b32 s77, s2, 7
    s_lshl_b32 s77, s77, 11
    s_bfe_u32 s82, s2, 0x10001
    s_sub_u32 s82, 1, s82
    s_lshl_b32 s82, s82, 10
    s_add_u32 s77, s77, s82
    s_bfe_u32 s82, s2, 0x50002
    s_lshl_b32 s82, s82, 5
    s_add_u32 s77, s77, s82
    s_and_b32 s82, s2, 1
    s_lshl_b32 s82, s82, 2
    s_add_u32 s77, s77, s82
    s_waitcnt lgkmcnt(0)
    s_add_u32 s76, s76, 0x9e3779b9
    s_add_u32 s84, s76, 0
    s_and_b32 s84, s84, 0x3ff
    s_add_u32 s85, s76, 341
    s_and_b32 s85, s85, 0x3ff
    s_add_u32 s86, s76, 682
    s_and_b32 s86, s86, 0x3ff
    s_add_u32 s87, s76, 1023
    s_and_b32 s87, s87, 0x3ff
    s_waitcnt vmcnt(6)
    v_lshlrev_b32 v72, 16, v8
    v_and_b32 v73, s92, v8
    v_pk_mul_f32 v[68:69], v[72:73], v[72:73]
    v_mov_b32 v64, v72
    v_mov_b32 v65, v73
    v_lshlrev_b32 v76, 16, v16
    v_and_b32 v77, s92, v16
    v_pk_mul_f32 v[70:71], v[76:77], v[76:77]
    v_mov_b32 v66, v76
    v_mov_b32 v67, v77
    v_lshlrev_b32 v74, 16, v9
    v_and_b32 v75, s92, v9
    v_pk_add_f32 v[64:65], v[64:65], v[74:75]
    v_pk_fma_f32 v[68:69], v[74:75], v[74:75], v[68:69]
    v_lshlrev_b32 v78, 16, v17
    v_and_b32 v79, s92, v17
    v_pk_add_f32 v[66:67], v[66:67], v[78:79]
    v_pk_fma_f32 v[70:71], v[78:79], v[78:79], v[70:71]
    v_lshlrev_b32 v72, 16, v10
    v_and_b32 v73, s92, v10
    v_pk_add_f32 v[64:65], v[64:65], v[72:73]
    v_pk_fma_f32 v[68:69], v[72:73], v[72:73], v[68:69]
    v_lshlrev_b32 v76, 16, v18
    v_and_b32 v77, s92, v18
    v_pk_add_f32 v[66:67], v[66:67], v[76:77]
    v_pk_fma_f32 v[70:71], v[76:77], v[76:77], v[70:71]
    v_lshlrev_b32 v74, 16, v11
    v_and_b32 v75, s92, v11
    v_pk_add_f32 v[64:65], v[64:65], v[74:75]
    v_pk_fma_f32 v[68:69], v[74:75], v[74:75], v[68:69]
    v_lshlrev_b32 v78, 16, v19
    v_and_b32 v79, s92, v19
    v_pk_add_f32 v[66:67], v[66:67], v[78:79]
    v_pk_fma_f32 v[70:71], v[78:79], v[78:79], v[70:71]
    v_lshlrev_b32 v72, 16, v12
    v_and_b32 v73, s92, v12
    v_pk_add_f32 v[64:65], v[64:65], v[72:73]
    v_pk_fma_f32 v[68:69], v[72:73], v[72:73], v[68:69]
    v_lshlrev_b32 v76, 16, v20
    v_and_b32 v77, s92, v20
    v_pk_add_f32 v[66:67], v[66:67], v[76:77]
    v_pk_fma_f32 v[70:71], v[76:77], v[76:77], v[70:71]
    v_lshlrev_b32 v74, 16, v13
    v_and_b32 v75, s92, v13
    v_pk_add_f32 v[64:65], v[64:65], v[74:75]
    v_pk_fma_f32 v[68:69], v[74:75], v[74:75], v[68:69]
    v_lshlrev_b32 v78, 16, v21
    v_and_b32 v79, s92, v21
    v_pk_add_f32 v[66:67], v[66:67], v[78:79]
    v_pk_fma_f32 v[70:71], v[78:79], v[78:79], v[70:71]
    v_lshlrev_b32 v72, 16, v14
    v_and_b32 v73, s92, v14
    v_pk_add_f32 v[64:65], v[64:65], v[72:73]
    v_pk_fma_f32 v[68:69], v[72:73], v[72:73], v[68:69]
    v_lshlrev_b32 v76, 16, v22
    v_and_b32 v77, s92, v22
    v_pk_add_f32 v[66:67], v[66:67], v[76:77]
    v_pk_fma_f32 v[70:71], v[76:77], v[76:77], v[70:71]
    v_lshlrev_b32 v74, 16, v15
    v_and_b32 v75, s92, v15
    v_pk_add_f32 v[64:65], v[64:65], v[74:75]
    v_pk_fma_f32 v[68:69], v[74:75], v[74:75], v[68:69]
    v_lshlrev_b32 v78, 16, v23
    v_and_b32 v79, s92, v23
    v_pk_add_f32 v[66:67], v[66:67], v[78:79]
    v_pk_fma_f32 v[70:71], v[78:79], v[78:79], v[70:71]
    v_add_f32 v64, v64, v65
    v_add_f32 v66, v66, v67
    v_add_f32 v68, v68, v69
    v_add_f32 v70, v70, v71
    v_permlane32_swap_b32 v64, v66
    s_nop 0
    v_permlane32_swap_b32 v68, v70
    v_add_f32 v64, v64, v66
    v_add_f32 v68, v68, v70
    s_nop 1
    v_permlane16_swap_b32 v64, v68
    v_add_f32 v64, v64, v68
    s_nop 1
    v_add_f32_dpp v64, v64, v64 row_ror:8 row_mask:0xf bank_mask:0xf
    s_nop 1
    v_add_f32_dpp v64, v64, v64 row_ror:4 row_mask:0xf bank_mask:0xf
    s_nop 1
    v_add_f32_dpp v64, v64, v64 row_ror:2 row_mask:0xf bank_mask:0xf
    s_nop 1
    v_add_f32_dpp v64, v64, v64 row_ror:1 row_mask:0xf bank_mask:0xf
    buffer_load_dwordx4 v[136:139], v2, s[36:39], s80 offen offset:128 nt
    v_readlane_b32 s30, v64, 0
    v_readlane_b32 s31, v64, 16
    v_readlane_b32 s82, v64, 32
    v_readlane_b32 s83, v64, 48
    v_mov_b32 v72, 0x3a800000
    v_mul_f32 v64, s30, v72
    v_mul_f32 v65, s82, v72
    v_mul_f32 v66, s31, v72
    v_mul_f32 v67, s83, v72
    v_fma_f32 v66, -v64, v64, v66
    v_fma_f32 v67, -v65, v65, v67
    v_cvt_pk_bf16_f32 v72, v64, v65
    v_lshlrev_b32 v64, 16, v72
    v_and_b32 v65, s92, v72
    v_cvt_pk_bf16_f32 v73, v66, v67
    v_lshlrev_b32 v66, 16, v73
    v_and_b32 v67, s92, v73
    v_add_f32 v66, 0x3727c5ac, v66
    v_add_f32 v67, 0x3727c5ac, v67
    v_cvt_pk_bf16_f32 v72, v66, v67
    v_lshlrev_b32 v66, 16, v72
    v_and_b32 v67, s92, v72
    v_sqrt_f32 v66, v66
    v_sqrt_f32 v67, v67
    s_nop 0
    v_cvt_pk_bf16_f32 v72, v66, v67
    v_lshlrev_b32 v66, 16, v72
    v_and_b32 v67, s92, v72
    v_rcp_f32 v68, v66
    v_rcp_f32 v69, v67
    v_lshlrev_b32 v80, 16, v24
    v_and_b32 v81, s92, v24
    v_sub_f32 v80, v80, v64
    v_sub_f32 v81, v81, v64
    v_cvt_pk_bf16_f32 v72, v80, v81
    v_lshlrev_b32 v80, 16, v72
    v_and_b32 v81, s92, v72
    v_lshlrev_b32 v82, 16, v25
    v_and_b32 v83, s92, v25
    v_sub_f32 v82, v82, v64
    v_sub_f32 v83, v83, v64
    v_cvt_pk_bf16_f32 v73, v82, v83
    v_lshlrev_b32 v82, 16, v73
    v_and_b32 v83, s92, v73
    v_lshlrev_b32 v84, 16, v26
    v_and_b32 v85, s92, v26
    v_sub_f32 v84, v84, v65
    v_sub_f32 v85, v85, v65
    v_cvt_pk_bf16_f32 v72, v84, v85
    v_lshlrev_b32 v84, 16, v72
    v_and_b32 v85, s92, v72
    v_lshlrev_b32 v86, 16, v27
    v_and_b32 v87, s92, v27
    v_sub_f32 v86, v86, v65
    v_sub_f32 v87, v87, v65
    v_cvt_pk_bf16_f32 v73, v86, v87
    v_lshlrev_b32 v86, 16, v73
    v_and_b32 v87, s92, v73
    v_mul_f32 v72, v80, v68
    v_mul_f32 v73, v81, v68
    v_mul_f32 v74, v82, v68
    v_mul_f32 v75, v83, v68
    v_fma_f32 v80, -v72, v66, v80
    v_fma_f32 v81, -v73, v66, v81
    v_fma_f32 v82, -v74, v66, v82
    v_fma_f32 v83, -v75, v66, v83
    v_fma_f32 v80, v80, v68, v72
    v_fma_f32 v81, v81, v68, v73
    v_fma_f32 v82, v82, v68, v74
    v_fma_f32 v83, v83, v68, v75
    v_cvt_pk_bf16_f32 v76, v80, v81
    v_lshlrev_b32 v80, 16, v76
    v_and_b32 v81, s92, v76
    v_cvt_pk_bf16_f32 v77, v82, v83
    v_lshlrev_b32 v82, 16, v77
    v_and_b32 v83, s92, v77
    v_mul_f32 v72, v84, v69
    v_mul_f32 v73, v85, v69
    v_mul_f32 v74, v86, v69
    v_mul_f32 v75, v87, v69
    v_fma_f32 v84, -v72, v67, v84
    v_fma_f32 v85, -v73, v67, v85
    v_fma_f32 v86, -v74, v67, v86
    v_fma_f32 v87, -v75, v67, v87
    v_fma_f32 v84, v84, v69, v72
    v_fma_f32 v85, v85, v69, v73
    v_fma_f32 v86, v86, v69, v74
    v_fma_f32 v87, v87, v69, v75
    v_cvt_pk_bf16_f32 v76, v84, v85
    v_lshlrev_b32 v84, 16, v76
    v_and_b32 v85, s92, v76
    v_cvt_pk_bf16_f32 v77, v86, v87
    v_lshlrev_b32 v86, 16, v77
    v_and_b32 v87, s92, v77
    buffer_load_dwordx4 v[140:143], v63, s[36:39], s80 offen offset:128 nt
    s_waitcnt vmcnt(4)
    v_lshlrev_b32 v72, 16, v28
    v_and_b32 v73, s92, v28
    v_pk_mul_f32 v[44:45], v[72:73], v[80:81] op_sel_hi:[1,0]
    v_pk_mul_f32 v[52:53], v[72:73], v[84:85] op_sel_hi:[1,0]
    v_lshlrev_b32 v74, 16, v29
    v_and_b32 v75, s92, v29
    v_pk_mul_f32 v[46:47], v[74:75], v[80:81] op_sel_hi:[1,0]
    v_pk_mul_f32 v[54:55], v[74:75], v[84:85] op_sel_hi:[1,0]
    v_lshlrev_b32 v72, 16, v30
    v_and_b32 v73, s92, v30
    v_pk_mul_f32 v[48:49], v[72:73], v[80:81] op_sel_hi:[1,0]
    v_pk_mul_f32 v[56:57], v[72:73], v[84:85] op_sel_hi:[1,0]
    v_lshlrev_b32 v74, 16, v31
    v_and_b32 v75, s92, v31
    v_pk_mul_f32 v[50:51], v[74:75], v[80:81] op_sel_hi:[1,0]
    v_pk_mul_f32 v[58:59], v[74:75], v[84:85] op_sel_hi:[1,0]
    v_lshlrev_b32 v76, 16, v32
    v_and_b32 v77, s92, v32
    v_pk_fma_f32 v[44:45], v[76:77], v[80:81], v[44:45] op_sel:[0,1,0] op_sel_hi:[1,1,1]
    v_pk_fma_f32 v[52:53], v[76:77], v[84:85], v[52:53] op_sel:[0,1,0] op_sel_hi:[1,1,1]
    v_lshlrev_b32 v78, 16, v33
    v_and_b32 v79, s92, v33
    v_pk_fma_f32 v[46:47], v[78:79], v[80:81], v[46:47] op_sel:[0,1,0] op_sel_hi:[1,1,1]
    v_pk_fma_f32 v[54:55], v[78:79], v[84:85], v[54:55] op_sel:[0,1,0] op_sel_hi:[1,1,1]
    v_lshlrev_b32 v76, 16, v34
    v_and_b32 v77, s92, v34
    v_pk_fma_f32 v[48:49], v[76:77], v[80:81], v[48:49] op_sel:[0,1,0] op_sel_hi:[1,1,1]
    v_pk_fma_f32 v[56:57], v[76:77], v[84:85], v[56:57] op_sel:[0,1,0] op_sel_hi:[1,1,1]
    v_lshlrev_b32 v78, 16, v35
    v_and_b32 v79, s92, v35
    v_pk_fma_f32 v[50:51], v[78:79], v[80:81], v[50:51] op_sel:[0,1,0] op_sel_hi:[1,1,1]
    v_pk_fma_f32 v[58:59], v[78:79], v[84:85], v[58:59] op_sel:[0,1,0] op_sel_hi:[1,1,1]
    v_lshlrev_b32 v72, 16, v36
    v_and_b32 v73, s92, v36
    v_pk_fma_f32 v[44:45], v[72:73], v[82:83], v[44:45] op_sel_hi:[1,0,1]
    v_pk_fma_f32 v[52:53], v[72:73], v[86:87], v[52:53] op_sel_hi:[1,0,1]
    v_lshlrev_b32 v74, 16, v37
    v_and_b32 v75, s92, v37
    v_pk_fma_f32 v[46:47], v[74:75], v[82:83], v[46:47] op_sel_hi:[1,0,1]
    v_pk_fma_f32 v[54:55], v[74:75], v[86:87], v[54:55] op_sel_hi:[1,0,1]
    v_lshlrev_b32 v72, 16, v38
    v_and_b32 v73, s92, v38
    v_pk_fma_f32 v[48:49], v[72:73], v[82:83], v[48:49] op_sel_hi:[1,0,1]
    v_pk_fma_f32 v[56:57], v[72:73], v[86:87], v[56:57] op_sel_hi:[1,0,1]
    v_lshlrev_b32 v74, 16, v39
    v_and_b32 v75, s92, v39
    v_pk_fma_f32 v[50:51], v[74:75], v[82:83], v[50:51] op_sel_hi:[1,0,1]
    v_pk_fma_f32 v[58:59], v[74:75], v[86:87], v[58:59] op_sel_hi:[1,0,1]
    v_lshlrev_b32 v76, 16, v40
    v_and_b32 v77, s92, v40
    v_pk_fma_f32 v[44:45], v[76:77], v[82:83], v[44:45] op_sel:[0,1,0] op_sel_hi:[1,1,1]
    v_pk_fma_f32 v[52:53], v[76:77], v[86:87], v[52:53] op_sel:[0,1,0] op_sel_hi:[1,1,1]
    v_lshlrev_b32 v78, 16, v41
    v_and_b32 v79, s92, v41
    v_pk_fma_f32 v[46:47], v[78:79], v[82:83], v[46:47] op_sel:[0,1,0] op_sel_hi:[1,1,1]
    v_pk_fma_f32 v[54:55], v[78:79], v[86:87], v[54:55] op_sel:[0,1,0] op_sel_hi:[1,1,1]
    v_lshlrev_b32 v76, 16, v42
    v_and_b32 v77, s92, v42
    v_pk_fma_f32 v[48:49], v[76:77], v[82:83], v[48:49] op_sel:[0,1,0] op_sel_hi:[1,1,1]
    v_pk_fma_f32 v[56:57], v[76:77], v[86:87], v[56:57] op_sel:[0,1,0] op_sel_hi:[1,1,1]
    v_lshlrev_b32 v78, 16, v43
    v_and_b32 v79, s92, v43
    v_pk_fma_f32 v[50:51], v[78:79], v[82:83], v[50:51] op_sel:[0,1,0] op_sel_hi:[1,1,1]
    v_pk_fma_f32 v[58:59], v[78:79], v[86:87], v[58:59] op_sel:[0,1,0] op_sel_hi:[1,1,1]
    s_add_u32 s80, s80, 4096
    buffer_load_dwordx4 v[144:147], v2, s[36:39], s80 offen offset:0 nt
    v_permlane32_swap_b32 v44, v52
    v_permlane32_swap_b32 v45, v53
    v_permlane32_swap_b32 v46, v54
    v_permlane32_swap_b32 v47, v55
    v_permlane32_swap_b32 v48, v56
    v_permlane32_swap_b32 v49, v57
    v_permlane32_swap_b32 v50, v58
    v_permlane32_swap_b32 v51, v59
    v_add_f32 v44, v44, v52
    v_add_f32 v45, v45, v53
    v_add_f32 v46, v46, v54
    v_add_f32 v47, v47, v55
    v_add_f32 v48, v48, v56
    v_add_f32 v49, v49, v57
    v_add_f32 v50, v50, v58
    v_add_f32 v51, v51, v59
    v_permlane16_swap_b32 v44, v48
    v_permlane16_swap_b32 v45, v49
    v_permlane16_swap_b32 v46, v50
    v_permlane16_swap_b32 v47, v51
    v_add_f32 v44, v44, v48
    v_add_f32 v45, v45, v49
    v_add_f32 v46, v46, v50
    v_add_f32 v47, v47, v51
    v_add_f32_dpp v44, v44, v44 row_ror:8 row_mask:0xf bank_mask:0xf
    v_add_f32_dpp v45, v45, v45 row_ror:8 row_mask:0xf bank_mask:0xf
    v_add_f32_dpp v46, v46, v46 row_ror:8 row_mask:0xf bank_mask:0xf
    v_add_f32_dpp v47, v47, v47 row_ror:8 row_mask:0xf bank_mask:0xf
    v_lshrrev_b32 v4, 5, v1
    v_lshlrev_b32 v4, 8, v4
    v_and_b32 v5, 7, v1
    v_lshlrev_b32 v5, 5, v5
    v_and_b32 v6, 16, v1
    v_or3_b32 v4, v4, v5, v6
    s_lshl_b32 s82, s3, 9
    v_add_u32 v4, s82, v4
    s_mov_b32 exec_lo, 0x00ff00ff
    s_mov_b32 exec_hi, 0x00ff00ff
    ds_write_b128 v4, v[44:47] offset:8192
    s_mov_b64 exec, 1
    v_mov_b32 v4, 0
    v_mov_b32 v5, 0
    v_mov_b32 v6, 0
    ds_write_b64 v6, v[4:5] offset:512
    v_mov_b32 v7, 0
    ds_write_b128 v6, v[4:7] offset:528
    s_mov_b64 exec, -1
    s_waitcnt lgkmcnt(0)
    s_barrier
    buffer_load_dwordx4 v[148:151], v63, s[36:39], s80 offen offset:0 nt
    s_cmp_lg_u32 s3, 0
    s_cbranch_scc1 L_qpub_done
    v_lshlrev_b32 v4, 4, v1
    s_mov_b32 exec_lo, -1
    s_mov_b32 exec_hi, 0
    ds_read_b128 v[8:11], v4 offset:8192
    ds_read_b128 v[12:15], v4 offset:8704
    ds_read_b128 v[16:19], v4 offset:9216
    ds_read_b128 v[20:23], v4 offset:9728
    ds_read_b128 v[24:27], v4 offset:10240
    ds_read_b128 v[28:31], v4 offset:10752
    ds_read_b128 v[32:35], v4 offset:11264
    ds_read_b128 v[36:39], v4 offset:11776
    v_lshrrev_b32 v6, 4, v1
    v_lshlrev_b32 v6, 14, v6
    v_and_b32 v5, 15, v1
    v_lshlrev_b32 v5, 4, v5
    v_add_u32 v6, v6, v5
    s_lshr_b32 s82, s88, 6
    s_lshl_b32 s82, s82, 15
    s_and_b32 s83, s88, 63
    s_lshl_b32 s83, s83, 8
    s_add_u32 s82, s82, s83
    s_add_u32 s82, s82, 4096
    v_and_b32 v40, 15, s84
    v_and_b32 v41, 15, s85
    v_and_b32 v42, 15, s86
    v_and_b32 v43, 15, s87
    s_waitcnt lgkmcnt(4)
    v_pk_add_f32 v[8:9], v[8:9], v[12:13]
    v_pk_add_f32 v[10:11], v[10:11], v[14:15]
    v_pk_add_f32 v[16:17], v[16:17], v[20:21]
    v_pk_add_f32 v[18:19], v[18:19], v[22:23]
    v_pk_add_f32 v[8:9], v[8:9], v[16:17]
    v_pk_add_f32 v[10:11], v[10:11], v[18:19]
    s_waitcnt lgkmcnt(0)
    v_pk_add_f32 v[24:25], v[24:25], v[28:29]
    v_pk_add_f32 v[26:27], v[26:27], v[30:31]
    v_pk_add_f32 v[32:33], v[32:33], v[36:37]
    v_pk_add_f32 v[34:35], v[34:35], v[38:39]
    v_pk_add_f32 v[24:25], v[24:25], v[32:33]
    v_pk_add_f32 v[26:27], v[26:27], v[34:35]
    v_pk_add_f32 v[8:9], v[8:9], v[24:25]
    v_pk_add_f32 v[10:11], v[10:11], v[26:27]
    v_add_u32 v8, 8, v8
    v_add_u32 v9, 8, v9
    v_add_u32 v10, 8, v10
    v_add_u32 v11, 8, v11
    v_and_or_b32 v8, v8, -16, v40
    v_and_or_b32 v9, v9, -16, v41
    v_and_or_b32 v10, v10, -16, v42
    v_and_or_b32 v11, v11, -16, v43
    buffer_store_dwordx4 v[8:11], v6, s[64:67], s82 offen sc1
    s_mov_b64 exec, -1
L_qpub_done:
    buffer_load_dwordx4 v[152:155], v2, s[36:39], s80 offen offset:128 nt
    buffer_load_dwordx4 v[156:159], v63, s[36:39], s80 offen offset:128 nt
    s_add_u32 s80, s80, 4096
    buffer_load_dwordx4 v[160:163], v2, s[36:39], s80 offen offset:0 nt
    buffer_load_dwordx4 v[164:167], v63, s[36:39], s80 offen offset:0 nt
    s_waitcnt vmcnt(9)
    buffer_load_dwordx4 v[168:171], v2, s[36:39], s80 offen offset:128 nt
    s_waitcnt vmcnt(9)
    buffer_load_dwordx4 v[172:175], v63, s[36:39], s80 offen offset:128 nt
    v_mov_b32_dpp v56, v132 row_ror:8 row_mask:0xf bank_mask:0xc
    v_mov_b32_dpp v57, v133 row_ror:8 row_mask:0xf bank_mask:0xc
    v_mov_b32_dpp v58, v134 row_ror:8 row_mask:0xf bank_mask:0xc
    v_mov_b32_dpp v59, v135 row_ror:8 row_mask:0xf bank_mask:0xc
    v_mov_b32_dpp v56, v128 row_ror:8 row_mask:0xf bank_mask:0x3
    v_mov_b32_dpp v57, v129 row_ror:8 row_mask:0xf bank_mask:0x3
    v_mov_b32_dpp v58, v130 row_ror:8 row_mask:0xf bank_mask:0x3
    v_mov_b32_dpp v59, v131 row_ror:8 row_mask:0xf bank_mask:0x3
    v_mov_b32_dpp v128, v132 quad_perm:[0,1,2,3] row_mask:0xf bank_mask:0xc
    v_mov_b32_dpp v129, v133 quad_perm:[0,1,2,3] row_mask:0xf bank_mask:0xc
    v_mov_b32_dpp v130, v134 quad_perm:[0,1,2,3] row_mask:0xf bank_mask:0xc
    v_mov_b32_dpp v131, v135 quad_perm:[0,1,2,3] row_mask:0xf bank_mask:0xc
    s_waitcnt vmcnt(9)
    s_add_u32 s80, s80, 4096
    buffer_load_dwordx4 v[176:179], v2, s[36:39], s80 offen offset:0 nt
    s_waitcnt vmcnt(9)
    buffer_load_dwordx4 v[180:183], v63, s[36:39], s80 offen offset:0 nt
    v_mov_b32_dpp v132, v140 row_ror:8 row_mask:0xf bank_mask:0xc
    v_mov_b32_dpp v133, v141 row_ror:8 row_mask:0xf bank_mask:0xc
    v_mov_b32_dpp v134, v142 row_ror:8 row_mask:0xf bank_mask:0xc
    v_mov_b32_dpp v135, v143 row_ror:8 row_mask:0xf bank_mask:0xc
    v_mov_b32_dpp v132, v136 row_ror:8 row_mask:0xf bank_mask:0x3
    v_mov_b32_dpp v133, v137 row_ror:8 row_mask:0xf bank_mask:0x3
    v_mov_b32_dpp v134, v138 row_ror:8 row_mask:0xf bank_mask:0x3
    v_mov_b32_dpp v135, v139 row_ror:8 row_mask:0xf bank_mask:0x3
    v_mov_b32_dpp v136, v140 quad_perm:[0,1,2,3] row_mask:0xf bank_mask:0xc
    v_mov_b32_dpp v137, v141 quad_perm:[0,1,2,3] row_mask:0xf bank_mask:0xc
    v_mov_b32_dpp v138, v142 quad_perm:[0,1,2,3] row_mask:0xf bank_mask:0xc
    v_mov_b32_dpp v139, v143 quad_perm:[0,1,2,3] row_mask:0xf bank_mask:0xc
    s_waitcnt vmcnt(9)
    buffer_load_dwordx4 v[184:187], v2, s[36:39], s80 offen offset:128 nt
    s_waitcnt vmcnt(9)
    buffer_load_dwordx4 v[188:191], v63, s[36:39], s80 offen offset:128 nt
    v_mov_b32_dpp v140, v148 row_ror:8 row_mask:0xf bank_mask:0xc
    v_mov_b32_dpp v141, v149 row_ror:8 row_mask:0xf bank_mask:0xc
    v_mov_b32_dpp v142, v150 row_ror:8 row_mask:0xf bank_mask:0xc
    v_mov_b32_dpp v143, v151 row_ror:8 row_mask:0xf bank_mask:0xc
    v_mov_b32_dpp v140, v144 row_ror:8 row_mask:0xf bank_mask:0x3
    v_mov_b32_dpp v141, v145 row_ror:8 row_mask:0xf bank_mask:0x3
    v_mov_b32_dpp v142, v146 row_ror:8 row_mask:0xf bank_mask:0x3
    v_mov_b32_dpp v143, v147 row_ror:8 row_mask:0xf bank_mask:0x3
    v_mov_b32_dpp v144, v148 quad_perm:[0,1,2,3] row_mask:0xf bank_mask:0xc
    v_mov_b32_dpp v145, v149 quad_perm:[0,1,2,3] row_mask:0xf bank_mask:0xc
    v_mov_b32_dpp v146, v150 quad_perm:[0,1,2,3] row_mask:0xf bank_mask:0xc
    v_mov_b32_dpp v147, v151 quad_perm:[0,1,2,3] row_mask:0xf bank_mask:0xc
    s_waitcnt vmcnt(9)
    s_add_u32 s80, s80, 4096
    buffer_load_dwordx4 v[192:195], v2, s[36:39], s80 offen offset:0 nt
    s_waitcnt vmcnt(9)
    buffer_load_dwordx4 v[196:199], v63, s[36:39], s80 offen offset:0 nt
    v_mov_b32_dpp v148, v156 row_ror:8 row_mask:0xf bank_mask:0xc
    v_mov_b32_dpp v149, v157 row_ror:8 row_mask:0xf bank_mask:0xc
    v_mov_b32_dpp v150, v158 row_ror:8 row_mask:0xf bank_mask:0xc
    v_mov_b32_dpp v151, v159 row_ror:8 row_mask:0xf bank_mask:0xc
    v_mov_b32_dpp v148, v152 row_ror:8 row_mask:0xf bank_mask:0x3
    v_mov_b32_dpp v149, v153 row_ror:8 row_mask:0xf bank_mask:0x3
    v_mov_b32_dpp v150, v154 row_ror:8 row_mask:0xf bank_mask:0x3
    v_mov_b32_dpp v151, v155 row_ror:8 row_mask:0xf bank_mask:0x3
    v_mov_b32_dpp v152, v156 quad_perm:[0,1,2,3] row_mask:0xf bank_mask:0xc
    v_mov_b32_dpp v153, v157 quad_perm:[0,1,2,3] row_mask:0xf bank_mask:0xc
    v_mov_b32_dpp v154, v158 quad_perm:[0,1,2,3] row_mask:0xf bank_mask:0xc
    v_mov_b32_dpp v155, v159 quad_perm:[0,1,2,3] row_mask:0xf bank_mask:0xc
    s_waitcnt vmcnt(9)
    buffer_load_dwordx4 v[200:203], v2, s[36:39], s80 offen offset:128 nt
    s_waitcnt vmcnt(9)
    buffer_load_dwordx4 v[204:207], v63, s[36:39], s80 offen offset:128 nt
    v_mov_b32_dpp v156, v164 row_ror:8 row_mask:0xf bank_mask:0xc
    v_mov_b32_dpp v157, v165 row_ror:8 row_mask:0xf bank_mask:0xc
    v_mov_b32_dpp v158, v166 row_ror:8 row_mask:0xf bank_mask:0xc
    v_mov_b32_dpp v159, v167 row_ror:8 row_mask:0xf bank_mask:0xc
    v_mov_b32_dpp v156, v160 row_ror:8 row_mask:0xf bank_mask:0x3
    v_mov_b32_dpp v157, v161 row_ror:8 row_mask:0xf bank_mask:0x3
    v_mov_b32_dpp v158, v162 row_ror:8 row_mask:0xf bank_mask:0x3
    v_mov_b32_dpp v159, v163 row_ror:8 row_mask:0xf bank_mask:0x3
    v_mov_b32_dpp v160, v164 quad_perm:[0,1,2,3] row_mask:0xf bank_mask:0xc
    v_mov_b32_dpp v161, v165 quad_perm:[0,1,2,3] row_mask:0xf bank_mask:0xc
    v_mov_b32_dpp v162, v166 quad_perm:[0,1,2,3] row_mask:0xf bank_mask:0xc
    v_mov_b32_dpp v163, v167 quad_perm:[0,1,2,3] row_mask:0xf bank_mask:0xc
    v_lshrrev_b32 v4, 5, v1
    v_lshlrev_b32 v4, 15, v4
    v_and_b32 v5, 31, v1
    v_lshl_or_b32 v4, v5, 4, v4
    v_add_u32 v5, 0x10000, v4
    buffer_load_dwordx4 v[8:11], v4, s[64:67], s95 offen sc1
    buffer_load_dwordx4 v[12:15], v5, s[64:67], s95 offen sc1
    s_waitcnt vmcnt(11)
    s_add_u32 s80, s80, 4096
    buffer_load_dwordx4 v[208:211], v2, s[36:39], s80 offen offset:0 nt
    s_waitcnt vmcnt(11)
    buffer_load_dwordx4 v[212:215], v63, s[36:39], s80 offen offset:0 nt
    v_mov_b32_dpp v164, v172 row_ror:8 row_mask:0xf bank_mask:0xc
    v_mov_b32_dpp v165, v173 row_ror:8 row_mask:0xf bank_mask:0xc
    v_mov_b32_dpp v166, v174 row_ror:8 row_mask:0xf bank_mask:0xc
    v_mov_b32_dpp v167, v175 row_ror:8 row_mask:0xf bank_mask:0xc
    v_mov_b32_dpp v164, v168 row_ror:8 row_mask:0xf bank_mask:0x3
    v_mov_b32_dpp v165, v169 row_ror:8 row_mask:0xf bank_mask:0x3
    v_mov_b32_dpp v166, v170 row_ror:8 row_mask:0xf bank_mask:0x3
    v_mov_b32_dpp v167, v171 row_ror:8 row_mask:0xf bank_mask:0x3
    v_mov_b32_dpp v168, v172 quad_perm:[0,1,2,3] row_mask:0xf bank_mask:0xc
    v_mov_b32_dpp v169, v173 quad_perm:[0,1,2,3] row_mask:0xf bank_mask:0xc
    v_mov_b32_dpp v170, v174 quad_perm:[0,1,2,3] row_mask:0xf bank_mask:0xc
    v_mov_b32_dpp v171, v175 quad_perm:[0,1,2,3] row_mask:0xf bank_mask:0xc
    s_waitcnt vmcnt(11)
    buffer_load_dwordx4 v[216:219], v2, s[36:39], s80 offen offset:128 nt
    s_waitcnt vmcnt(11)
    buffer_load_dwordx4 v[220:223], v63, s[36:39], s80 offen offset:128 nt
    v_mov_b32_dpp v172, v180 row_ror:8 row_mask:0xf bank_mask:0xc
    v_mov_b32_dpp v173, v181 row_ror:8 row_mask:0xf bank_mask:0xc
    v_mov_b32_dpp v174, v182 row_ror:8 row_mask:0xf bank_mask:0xc
    v_mov_b32_dpp v175, v183 row_ror:8 row_mask:0xf bank_mask:0xc
    v_mov_b32_dpp v172, v176 row_ror:8 row_mask:0xf bank_mask:0x3
    v_mov_b32_dpp v173, v177 row_ror:8 row_mask:0xf bank_mask:0x3
    v_mov_b32_dpp v174, v178 row_ror:8 row_mask:0xf bank_mask:0x3
    v_mov_b32_dpp v175, v179 row_ror:8 row_mask:0xf bank_mask:0x3
    v_mov_b32_dpp v176, v180 quad_perm:[0,1,2,3] row_mask:0xf bank_mask:0xc
    v_mov_b32_dpp v177, v181 quad_perm:[0,1,2,3] row_mask:0xf bank_mask:0xc
    v_mov_b32_dpp v178, v182 quad_perm:[0,1,2,3] row_mask:0xf bank_mask:0xc
    v_mov_b32_dpp v179, v183 quad_perm:[0,1,2,3] row_mask:0xf bank_mask:0xc
    s_waitcnt vmcnt(11)
    s_add_u32 s80, s80, 4096
    buffer_load_dwordx4 v[224:227], v2, s[36:39], s80 offen offset:0 nt
    s_waitcnt vmcnt(11)
    buffer_load_dwordx4 v[228:231], v63, s[36:39], s80 offen offset:0 nt
    v_mov_b32_dpp v180, v188 row_ror:8 row_mask:0xf bank_mask:0xc
    v_mov_b32_dpp v181, v189 row_ror:8 row_mask:0xf bank_mask:0xc
    v_mov_b32_dpp v182, v190 row_ror:8 row_mask:0xf bank_mask:0xc
    v_mov_b32_dpp v183, v191 row_ror:8 row_mask:0xf bank_mask:0xc
    v_mov_b32_dpp v180, v184 row_ror:8 row_mask:0xf bank_mask:0x3
    v_mov_b32_dpp v181, v185 row_ror:8 row_mask:0xf bank_mask:0x3
    v_mov_b32_dpp v182, v186 row_ror:8 row_mask:0xf bank_mask:0x3
    v_mov_b32_dpp v183, v187 row_ror:8 row_mask:0xf bank_mask:0x3
    v_mov_b32_dpp v184, v188 quad_perm:[0,1,2,3] row_mask:0xf bank_mask:0xc
    v_mov_b32_dpp v185, v189 quad_perm:[0,1,2,3] row_mask:0xf bank_mask:0xc
    v_mov_b32_dpp v186, v190 quad_perm:[0,1,2,3] row_mask:0xf bank_mask:0xc
    v_mov_b32_dpp v187, v191 quad_perm:[0,1,2,3] row_mask:0xf bank_mask:0xc
    s_waitcnt vmcnt(11)
    buffer_load_dwordx4 v[232:235], v2, s[36:39], s80 offen offset:128 nt
    s_waitcnt vmcnt(11)
    buffer_load_dwordx4 v[236:239], v63, s[36:39], s80 offen offset:128 nt
    v_mov_b32_dpp v188, v196 row_ror:8 row_mask:0xf bank_mask:0xc
    v_mov_b32_dpp v189, v197 row_ror:8 row_mask:0xf bank_mask:0xc
    v_mov_b32_dpp v190, v198 row_ror:8 row_mask:0xf bank_mask:0xc
    v_mov_b32_dpp v191, v199 row_ror:8 row_mask:0xf bank_mask:0xc
    v_mov_b32_dpp v188, v192 row_ror:8 row_mask:0xf bank_mask:0x3
    v_mov_b32_dpp v189, v193 row_ror:8 row_mask:0xf bank_mask:0x3
    v_mov_b32_dpp v190, v194 row_ror:8 row_mask:0xf bank_mask:0x3
    v_mov_b32_dpp v191, v195 row_ror:8 row_mask:0xf bank_mask:0x3
    v_mov_b32_dpp v192, v196 quad_perm:[0,1,2,3] row_mask:0xf bank_mask:0xc
    v_mov_b32_dpp v193, v197 quad_perm:[0,1,2,3] row_mask:0xf bank_mask:0xc
    v_mov_b32_dpp v194, v198 quad_perm:[0,1,2,3] row_mask:0xf bank_mask:0xc
    v_mov_b32_dpp v195, v199 quad_perm:[0,1,2,3] row_mask:0xf bank_mask:0xc
    s_waitcnt vmcnt(8)
    v_and_b32 v20, 15, s84
    v_and_b32 v21, 15, s85
    v_and_b32 v22, 15, s86
    v_and_b32 v23, 15, s87
    v_xor_b32 v8, v20, v8
    v_xor_b32 v9, v21, v9
    v_xor_b32 v10, v22, v10
    v_xor_b32 v11, v23, v11
    v_xor_b32 v12, v20, v12
    v_xor_b32 v13, v21, v13
    v_xor_b32 v14, v22, v14
    v_xor_b32 v15, v23, v15
    v_or3_b32 v16, v8, v9, v10
    v_or3_b32 v17, v11, v12, v13
    v_or3_b32 v16, v16, v14, v15
    v_or_b32 v16, v16, v17
    v_and_b32 v16, 15, v16
    v_cmp_ne_u32 vcc, 0, v16
    s_cbranch_vccnz L_qretry
L_qok:
    v_pk_add_f32 v[8:9], v[8:9], v[12:13]
    v_pk_add_f32 v[10:11], v[10:11], v[14:15]
    v_and_b32 v5, 31, v1
    v_lshlrev_b32 v5, 3, v5
    v_lshrrev_b32 v6, 5, v1
    v_permlane32_swap_b32 v8, v10
    v_permlane32_swap_b32 v9, v11
    v_lshl_or_b32 v5, v6, 2, v5
    s_mul_i32 s82, s3, 272
    v_add_f32 v8, v8, v10
    v_add_f32 v9, v9, v11
    v_add_u32 v5, s82, v5
    v_cvt_pk_bf16_f32 v6, v8, v9
    ds_write_b32 v5, v6 offset:1024
    s_mov_b64 exec, 1
    v_mov_b32 v5, 0
    v_mov_b32 v6, 1
    ds_add_u32 v5, v6 offset:512
    s_mov_b64 exec, -1
    s_add_u32 s80, s80, 4096
    buffer_load_dwordx4 v[240:243], v2, s[36:39], s80 offen offset:0 nt
    v_mov_b32_dpp v196, v204 row_ror:8 row_mask:0xf bank_mask:0xc
    v_mov_b32_dpp v197, v205 row_ror:8 row_mask:0xf bank_mask:0xc
    v_mov_b32_dpp v198, v206 row_ror:8 row_mask:0xf bank_mask:0xc
    v_mov_b32_dpp v199, v207 row_ror:8 row_mask:0xf bank_mask:0xc
    v_mov_b32_dpp v196, v200 row_ror:8 row_mask:0xf bank_mask:0x3
    v_mov_b32_dpp v197, v201 row_ror:8 row_mask:0xf bank_mask:0x3
    v_mov_b32_dpp v198, v202 row_ror:8 row_mask:0xf bank_mask:0x3
    v_mov_b32_dpp v199, v203 row_ror:8 row_mask:0xf bank_mask:0x3
    v_mov_b32_dpp v200, v204 quad_perm:[0,1,2,3] row_mask:0xf bank_mask:0xc
    v_mov_b32_dpp v201, v205 quad_perm:[0,1,2,3] row_mask:0xf bank_mask:0xc
    v_mov_b32_dpp v202, v206 quad_perm:[0,1,2,3] row_mask:0xf bank_mask:0xc
    v_mov_b32_dpp v203, v207 quad_perm:[0,1,2,3] row_mask:0xf bank_mask:0xc
    buffer_load_dwordx4 v[244:247], v63, s[36:39], s80 offen offset:0 nt
    s_waitcnt vmcnt(9)
    buffer_load_dwordx4 v[248:251], v2, s[36:39], s80 offen offset:128 nt
    s_waitcnt vmcnt(9)
    buffer_load_dwordx4 v[252:255], v63, s[36:39], s80 offen offset:128 nt
    v_mov_b32_dpp v204, v212 row_ror:8 row_mask:0xf bank_mask:0xc
    v_mov_b32_dpp v205, v213 row_ror:8 row_mask:0xf bank_mask:0xc
    v_mov_b32_dpp v206, v214 row_ror:8 row_mask:0xf bank_mask:0xc
    v_mov_b32_dpp v207, v215 row_ror:8 row_mask:0xf bank_mask:0xc
    v_mov_b32_dpp v204, v208 row_ror:8 row_mask:0xf bank_mask:0x3
    v_mov_b32_dpp v205, v209 row_ror:8 row_mask:0xf bank_mask:0x3
    v_mov_b32_dpp v206, v210 row_ror:8 row_mask:0xf bank_mask:0x3
    v_mov_b32_dpp v207, v211 row_ror:8 row_mask:0xf bank_mask:0x3
    v_mov_b32_dpp v208, v212 quad_perm:[0,1,2,3] row_mask:0xf bank_mask:0xc
    v_mov_b32_dpp v209, v213 quad_perm:[0,1,2,3] row_mask:0xf bank_mask:0xc
    v_mov_b32_dpp v210, v214 quad_perm:[0,1,2,3] row_mask:0xf bank_mask:0xc
    v_mov_b32_dpp v211, v215 quad_perm:[0,1,2,3] row_mask:0xf bank_mask:0xc
    s_waitcnt vmcnt(9)
    buffer_load_dwordx4 v[64:67], v3, s[40:43], s81 offen offset:0 nt
    s_waitcnt vmcnt(9)
    buffer_load_dwordx4 v[68:71], v3, s[40:43], s81 offen offset:1024 nt
    v_mov_b32_dpp v212, v220 row_ror:8 row_mask:0xf bank_mask:0xc
    v_mov_b32_dpp v213, v221 row_ror:8 row_mask:0xf bank_mask:0xc
    v_mov_b32_dpp v214, v222 row_ror:8 row_mask:0xf bank_mask:0xc
    v_mov_b32_dpp v215, v223 row_ror:8 row_mask:0xf bank_mask:0xc
    v_mov_b32_dpp v212, v216 row_ror:8 row_mask:0xf bank_mask:0x3
    v_mov_b32_dpp v213, v217 row_ror:8 row_mask:0xf bank_mask:0x3
    v_mov_b32_dpp v214, v218 row_ror:8 row_mask:0xf bank_mask:0x3
    v_mov_b32_dpp v215, v219 row_ror:8 row_mask:0xf bank_mask:0x3
    v_mov_b32_dpp v216, v220 quad_perm:[0,1,2,3] row_mask:0xf bank_mask:0xc
    v_mov_b32_dpp v217, v221 quad_perm:[0,1,2,3] row_mask:0xf bank_mask:0xc
    v_mov_b32_dpp v218, v222 quad_perm:[0,1,2,3] row_mask:0xf bank_mask:0xc
    v_mov_b32_dpp v219, v223 quad_perm:[0,1,2,3] row_mask:0xf bank_mask:0xc
    s_waitcnt vmcnt(9)
    buffer_load_dwordx4 v[72:75], v3, s[40:43], s81 offen offset:2048 nt
    s_waitcnt vmcnt(9)
    buffer_load_dwordx4 v[76:79], v3, s[40:43], s81 offen offset:3072 nt
    v_mov_b32_dpp v220, v228 row_ror:8 row_mask:0xf bank_mask:0xc
    v_mov_b32_dpp v221, v229 row_ror:8 row_mask:0xf bank_mask:0xc
    v_mov_b32_dpp v222, v230 row_ror:8 row_mask:0xf bank_mask:0xc
    v_mov_b32_dpp v223, v231 row_ror:8 row_mask:0xf bank_mask:0xc
    v_mov_b32_dpp v220, v224 row_ror:8 row_mask:0xf bank_mask:0x3
    v_mov_b32_dpp v221, v225 row_ror:8 row_mask:0xf bank_mask:0x3
    v_mov_b32_dpp v222, v226 row_ror:8 row_mask:0xf bank_mask:0x3
    v_mov_b32_dpp v223, v227 row_ror:8 row_mask:0xf bank_mask:0x3
    v_mov_b32_dpp v224, v228 quad_perm:[0,1,2,3] row_mask:0xf bank_mask:0xc
    v_mov_b32_dpp v225, v229 quad_perm:[0,1,2,3] row_mask:0xf bank_mask:0xc
    v_mov_b32_dpp v226, v230 quad_perm:[0,1,2,3] row_mask:0xf bank_mask:0xc
    v_mov_b32_dpp v227, v231 quad_perm:[0,1,2,3] row_mask:0xf bank_mask:0xc
    v_mov_b32 v5, 0
    s_mov_b32 s93, 0
L_cq_poll:
    ds_read_b32 v6, v5 offset:512
    s_waitcnt lgkmcnt(0)
    v_readfirstlane_b32 s82, v6
    s_add_u32 s93, s93, 1
    s_cmp_ge_u32 s82, 8
    s_cbranch_scc1 L_cq_ok
    s_sleep 1
    s_cmp_lt_u32 s93, 160000
    s_cbranch_scc1 L_cq_poll
L_cq_ok:
    v_and_b32 v5, 7, v1
    v_mul_u32_u24 v5, 272, v5
    v_and_b32 v6, 0x30, v1
    v_add_u32 v5, v5, v6
    ds_read_b128 v[40:43], v5 offset:1024
    ds_read_b128 v[44:47], v5 offset:1088
    ds_read_b128 v[48:51], v5 offset:1152
    ds_read_b128 v[52:55], v5 offset:1216
    s_waitcnt vmcnt(9)
    s_add_u32 s81, s81, 4096
    buffer_load_dwordx4 v[80:83], v3, s[40:43], s81 offen offset:0 nt
    s_waitcnt lgkmcnt(0)
    v_mfma_f32_16x16x32_bf16 v[8:11], v[128:131], v[40:43], 0
    v_mfma_f32_16x16x32_bf16 v[8:11], v[56:59], v[44:47], v[8:11]
    v_mfma_f32_16x16x32_bf16 v[8:11], v[136:139], v[48:51], v[8:11]
    v_mfma_f32_16x16x32_bf16 v[8:11], v[132:135], v[52:55], v[8:11]
    v_mfma_f32_16x16x32_bf16 v[12:15], v[144:147], v[40:43], 0
    v_mfma_f32_16x16x32_bf16 v[12:15], v[140:143], v[44:47], v[12:15]
    v_mfma_f32_16x16x32_bf16 v[12:15], v[152:155], v[48:51], v[12:15]
    v_mfma_f32_16x16x32_bf16 v[12:15], v[148:151], v[52:55], v[12:15]
    v_mfma_f32_16x16x32_bf16 v[16:19], v[160:163], v[40:43], 0
    v_mfma_f32_16x16x32_bf16 v[16:19], v[156:159], v[44:47], v[16:19]
    v_mfma_f32_16x16x32_bf16 v[16:19], v[168:171], v[48:51], v[16:19]
    v_mfma_f32_16x16x32_bf16 v[16:19], v[164:167], v[52:55], v[16:19]
    v_mfma_f32_16x16x32_bf16 v[20:23], v[176:179], v[40:43], 0
    v_mfma_f32_16x16x32_bf16 v[20:23], v[172:175], v[44:47], v[20:23]
    v_mfma_f32_16x16x32_bf16 v[20:23], v[184:187], v[48:51], v[20:23]
    v_mfma_f32_16x16x32_bf16 v[20:23], v[180:183], v[52:55], v[20:23]
    v_mfma_f32_16x16x32_bf16 v[24:27], v[192:195], v[40:43], 0
    v_mfma_f32_16x16x32_bf16 v[24:27], v[188:191], v[44:47], v[24:27]
    v_mfma_f32_16x16x32_bf16 v[24:27], v[200:203], v[48:51], v[24:27]
    v_mfma_f32_16x16x32_bf16 v[24:27], v[196:199], v[52:55], v[24:27]
    v_mfma_f32_16x16x32_bf16 v[28:31], v[208:211], v[40:43], 0
    v_mfma_f32_16x16x32_bf16 v[28:31], v[204:207], v[44:47], v[28:31]
    v_mfma_f32_16x16x32_bf16 v[28:31], v[216:219], v[48:51], v[28:31]
    v_mfma_f32_16x16x32_bf16 v[28:31], v[212:215], v[52:55], v[28:31]
    s_waitcnt vmcnt(9)
    buffer_load_dwordx4 v[84:87], v3, s[40:43], s81 offen offset:1024 nt
    v_mov_b32_dpp v228, v236 row_ror:8 row_mask:0xf bank_mask:0xc
    v_mov_b32_dpp v229, v237 row_ror:8 row_mask:0xf bank_mask:0xc
    v_mov_b32_dpp v230, v238 row_ror:8 row_mask:0xf bank_mask:0xc
    v_mov_b32_dpp v231, v239 row_ror:8 row_mask:0xf bank_mask:0xc
    v_mov_b32_dpp v228, v232 row_ror:8 row_mask:0xf bank_mask:0x3
    v_mov_b32_dpp v229, v233 row_ror:8 row_mask:0xf bank_mask:0x3
    v_mov_b32_dpp v230, v234 row_ror:8 row_mask:0xf bank_mask:0x3
    v_mov_b32_dpp v231, v235 row_ror:8 row_mask:0xf bank_mask:0x3
    v_mov_b32_dpp v232, v236 quad_perm:[0,1,2,3] row_mask:0xf bank_mask:0xc
    v_mov_b32_dpp v233, v237 quad_perm:[0,1,2,3] row_mask:0xf bank_mask:0xc
    v_mov_b32_dpp v234, v238 quad_perm:[0,1,2,3] row_mask:0xf bank_mask:0xc
    v_mov_b32_dpp v235, v239 quad_perm:[0,1,2,3] row_mask:0xf bank_mask:0xc
    v_mfma_f32_16x16x32_bf16 v[32:35], v[224:227], v[40:43], 0
    v_mfma_f32_16x16x32_bf16 v[32:35], v[220:223], v[44:47], v[32:35]
    v_mfma_f32_16x16x32_bf16 v[32:35], v[232:235], v[48:51], v[32:35]
    v_mfma_f32_16x16x32_bf16 v[32:35], v[228:231], v[52:55], v[32:35]
    s_waitcnt vmcnt(9)
    buffer_load_dwordx4 v[88:91], v3, s[40:43], s81 offen offset:2048 nt
    s_waitcnt vmcnt(9)
    buffer_load_dwordx4 v[92:95], v3, s[40:43], s81 offen offset:3072 nt
    v_mov_b32_dpp v236, v244 row_ror:8 row_mask:0xf bank_mask:0xc
    v_mov_b32_dpp v237, v245 row_ror:8 row_mask:0xf bank_mask:0xc
    v_mov_b32_dpp v238, v246 row_ror:8 row_mask:0xf bank_mask:0xc
    v_mov_b32_dpp v239, v247 row_ror:8 row_mask:0xf bank_mask:0xc
    v_mov_b32_dpp v236, v240 row_ror:8 row_mask:0xf bank_mask:0x3
    v_mov_b32_dpp v237, v241 row_ror:8 row_mask:0xf bank_mask:0x3
    v_mov_b32_dpp v238, v242 row_ror:8 row_mask:0xf bank_mask:0x3
    v_mov_b32_dpp v239, v243 row_ror:8 row_mask:0xf bank_mask:0x3
    v_mov_b32_dpp v240, v244 quad_perm:[0,1,2,3] row_mask:0xf bank_mask:0xc
    v_mov_b32_dpp v241, v245 quad_perm:[0,1,2,3] row_mask:0xf bank_mask:0xc
    v_mov_b32_dpp v242, v246 quad_perm:[0,1,2,3] row_mask:0xf bank_mask:0xc
    v_mov_b32_dpp v243, v247 quad_perm:[0,1,2,3] row_mask:0xf bank_mask:0xc
    s_waitcnt vmcnt(9)
    s_add_u32 s81, s81, 4096
    buffer_load_dwordx4 v[96:99], v3, s[40:43], s81 offen offset:0 nt
    s_waitcnt vmcnt(9)
    v_mov_b32_dpp v244, v252 row_ror:8 row_mask:0xf bank_mask:0xc
    v_mov_b32_dpp v245, v253 row_ror:8 row_mask:0xf bank_mask:0xc
    v_mov_b32_dpp v246, v254 row_ror:8 row_mask:0xf bank_mask:0xc
    v_mov_b32_dpp v247, v255 row_ror:8 row_mask:0xf bank_mask:0xc
    v_mov_b32_dpp v244, v248 row_ror:8 row_mask:0xf bank_mask:0x3
    v_mov_b32_dpp v245, v249 row_ror:8 row_mask:0xf bank_mask:0x3
    v_mov_b32_dpp v246, v250 row_ror:8 row_mask:0xf bank_mask:0x3
    v_mov_b32_dpp v247, v251 row_ror:8 row_mask:0xf bank_mask:0x3
    v_mov_b32_dpp v248, v252 quad_perm:[0,1,2,3] row_mask:0xf bank_mask:0xc
    v_mov_b32_dpp v249, v253 quad_perm:[0,1,2,3] row_mask:0xf bank_mask:0xc
    v_mov_b32_dpp v250, v254 quad_perm:[0,1,2,3] row_mask:0xf bank_mask:0xc
    v_mov_b32_dpp v251, v255 quad_perm:[0,1,2,3] row_mask:0xf bank_mask:0xc
    v_mfma_f32_16x16x32_bf16 v[36:39], v[240:243], v[40:43], 0
    v_mfma_f32_16x16x32_bf16 v[36:39], v[236:239], v[44:47], v[36:39]
    v_mfma_f32_16x16x32_bf16 v[36:39], v[248:251], v[48:51], v[36:39]
    v_mfma_f32_16x16x32_bf16 v[36:39], v[244:247], v[52:55], v[36:39]
    v_mov_b32 v56, 0x3db504f3
    v_mov_b32 v57, 0x3db504f3
    v_cvt_pk_bf16_f32 v58, v8, v9
    v_lshlrev_b32 v8, 16, v58
    v_and_b32 v9, s92, v58
    v_pk_mul_f32 v[8:9], v[8:9], v[56:57]
    v_cvt_pk_bf16_f32 v58, v8, v9
    v_lshlrev_b32 v8, 16, v58
    v_and_b32 v9, s92, v58
    v_cvt_pk_bf16_f32 v59, v10, v11
    v_lshlrev_b32 v10, 16, v59
    v_and_b32 v11, s92, v59
    v_pk_mul_f32 v[10:11], v[10:11], v[56:57]
    v_cvt_pk_bf16_f32 v59, v10, v11
    v_lshlrev_b32 v10, 16, v59
    v_and_b32 v11, s92, v59
    v_cvt_pk_bf16_f32 v58, v12, v13
    v_lshlrev_b32 v12, 16, v58
    v_and_b32 v13, s92, v58
    v_pk_mul_f32 v[12:13], v[12:13], v[56:57]
    v_cvt_pk_bf16_f32 v58, v12, v13
    v_lshlrev_b32 v12, 16, v58
    v_and_b32 v13, s92, v58
    v_cvt_pk_bf16_f32 v59, v14, v15
    v_lshlrev_b32 v14, 16, v59
    v_and_b32 v15, s92, v59
    v_pk_mul_f32 v[14:15], v[14:15], v[56:57]
    v_cvt_pk_bf16_f32 v59, v14, v15
    v_lshlrev_b32 v14, 16, v59
    v_and_b32 v15, s92, v59
    v_cvt_pk_bf16_f32 v58, v16, v17
    v_lshlrev_b32 v16, 16, v58
    v_and_b32 v17, s92, v58
    v_pk_mul_f32 v[16:17], v[16:17], v[56:57]
    v_cvt_pk_bf16_f32 v58, v16, v17
    v_lshlrev_b32 v16, 16, v58
    v_and_b32 v17, s92, v58
    v_cvt_pk_bf16_f32 v59, v18, v19
    v_lshlrev_b32 v18, 16, v59
    v_and_b32 v19, s92, v59
    v_pk_mul_f32 v[18:19], v[18:19], v[56:57]
    v_cvt_pk_bf16_f32 v59, v18, v19
    v_lshlrev_b32 v18, 16, v59
    v_and_b32 v19, s92, v59
    v_cvt_pk_bf16_f32 v58, v20, v21
    v_lshlrev_b32 v20, 16, v58
    v_and_b32 v21, s92, v58
    v_pk_mul_f32 v[20:21], v[20:21], v[56:57]
    v_cvt_pk_bf16_f32 v58, v20, v21
    v_lshlrev_b32 v20, 16, v58
    v_and_b32 v21, s92, v58
    v_cvt_pk_bf16_f32 v59, v22, v23
    v_lshlrev_b32 v22, 16, v59
    v_and_b32 v23, s92, v59
    v_pk_mul_f32 v[22:23], v[22:23], v[56:57]
    v_cvt_pk_bf16_f32 v59, v22, v23
    v_lshlrev_b32 v22, 16, v59
    v_and_b32 v23, s92, v59
    buffer_load_dwordx4 v[100:103], v3, s[40:43], s81 offen offset:1024 nt
    v_cvt_pk_bf16_f32 v58, v24, v25
    v_lshlrev_b32 v24, 16, v58
    v_and_b32 v25, s92, v58
    v_pk_mul_f32 v[24:25], v[24:25], v[56:57]
    v_cvt_pk_bf16_f32 v58, v24, v25
    v_lshlrev_b32 v24, 16, v58
    v_and_b32 v25, s92, v58
    v_cvt_pk_bf16_f32 v59, v26, v27
    v_lshlrev_b32 v26, 16, v59
    v_and_b32 v27, s92, v59
    v_pk_mul_f32 v[26:27], v[26:27], v[56:57]
    v_cvt_pk_bf16_f32 v59, v26, v27
    v_lshlrev_b32 v26, 16, v59
    v_and_b32 v27, s92, v59
    v_cvt_pk_bf16_f32 v58, v28, v29
    v_lshlrev_b32 v28, 16, v58
    v_and_b32 v29, s92, v58
    v_pk_mul_f32 v[28:29], v[28:29], v[56:57]
    v_cvt_pk_bf16_f32 v58, v28, v29
    v_lshlrev_b32 v28, 16, v58
    v_and_b32 v29, s92, v58
    v_cvt_pk_bf16_f32 v59, v30, v31
    v_lshlrev_b32 v30, 16, v59
    v_and_b32 v31, s92, v59
    v_pk_mul_f32 v[30:31], v[30:31], v[56:57]
    v_cvt_pk_bf16_f32 v59, v30, v31
    v_lshlrev_b32 v30, 16, v59
    v_and_b32 v31, s92, v59
    v_cvt_pk_bf16_f32 v58, v32, v33
    v_lshlrev_b32 v32, 16, v58
    v_and_b32 v33, s92, v58
    v_pk_mul_f32 v[32:33], v[32:33], v[56:57]
    v_cvt_pk_bf16_f32 v58, v32, v33
    v_lshlrev_b32 v32, 16, v58
    v_and_b32 v33, s92, v58
    v_cvt_pk_bf16_f32 v59, v34, v35
    v_lshlrev_b32 v34, 16, v59
    v_and_b32 v35, s92, v59
    v_pk_mul_f32 v[34:35], v[34:35], v[56:57]
    v_cvt_pk_bf16_f32 v59, v34, v35
    v_lshlrev_b32 v34, 16, v59
    v_and_b32 v35, s92, v59
    v_cvt_pk_bf16_f32 v58, v36, v37
    v_lshlrev_b32 v36, 16, v58
    v_and_b32 v37, s92, v58
    v_pk_mul_f32 v[36:37], v[36:37], v[56:57]
    v_cvt_pk_bf16_f32 v58, v36, v37
    v_lshlrev_b32 v36, 16, v58
    v_and_b32 v37, s92, v58
    v_cvt_pk_bf16_f32 v59, v38, v39
    v_lshlrev_b32 v38, 16, v59
    v_and_b32 v39, s92, v59
    v_pk_mul_f32 v[38:39], v[38:39], v[56:57]
    v_cvt_pk_bf16_f32 v59, v38, v39
    v_lshlrev_b32 v38, 16, v59
    v_and_b32 v39, s92, v59
    v_max3_f32 v60, v8, v9, v10
    v_max3_f32 v61, v24, v25, v26
    v_max3_f32 v60, v60, v11, v12
    v_max3_f32 v61, v61, v27, v28
    v_max3_f32 v60, v60, v13, v14
    v_max3_f32 v61, v61, v29, v30
    v_max3_f32 v60, v60, v15, v16
    v_max3_f32 v61, v61, v31, v32
    v_max3_f32 v60, v60, v17, v18
    v_max3_f32 v61, v61, v33, v34
    v_max3_f32 v60, v60, v19, v20
    v_max3_f32 v61, v61, v35, v36
    v_max3_f32 v60, v60, v21, v22
    v_max3_f32 v61, v61, v37, v38
    v_max3_f32 v60, v60, v23, v39
    v_max_f32 v60, v60, v61
    v_mov_b32 v61, v60
    s_nop 1
    v_permlane16_swap_b32 v60, v61
    v_max_f32 v60, v60, v61
    v_mov_b32 v61, v60
    s_nop 1
    v_permlane32_swap_b32 v60, v61
    v_max_f32 v60, v60, v61
    v_lshlrev_b32 v4, 5, v1
    s_lshl_b32 s82, s3, 2
    v_add_u32 v4, s82, v4
    s_mov_b64 exec, 0xff
    ds_write_b32 v4, v60 offset:3328
    s_mov_b64 exec, -1
    v_mov_b32 v56, v60
    s_waitcnt vmcnt(9)
    buffer_load_dwordx4 v[104:107], v3, s[40:43], s81 offen offset:2048 nt
    v_lshlrev_b32 v6, 1, v0
    s_mov_b32 s93, 4096
    buffer_load_short_d16_hi v224, v6, s[52:55], 0 offen offset:0
    buffer_load_short_d16_hi v226, v6, s[52:55], 0 offen offset:1024
    buffer_load_short_d16_hi v228, v6, s[52:55], 0 offen offset:2048
    buffer_load_short_d16_hi v230, v6, s[52:55], 0 offen offset:3072
    buffer_load_short_d16_hi v232, v6, s[52:55], s93 offen offset:0
    buffer_load_short_d16_hi v234, v6, s[52:55], s93 offen offset:1024
    buffer_load_short_d16_hi v236, v6, s[52:55], s93 offen offset:2048
    buffer_load_short_d16_hi v225, v6, s[60:63], 0 offen offset:0
    buffer_load_short_d16_hi v227, v6, s[60:63], 0 offen offset:1024
    buffer_load_short_d16_hi v229, v6, s[60:63], 0 offen offset:2048
    buffer_load_short_d16_hi v231, v6, s[60:63], 0 offen offset:3072
    buffer_load_short_d16_hi v233, v6, s[60:63], s93 offen offset:0
    buffer_load_short_d16_hi v235, v6, s[60:63], s93 offen offset:1024
    buffer_load_short_d16_hi v237, v6, s[60:63], s93 offen offset:2048
    buffer_load_short_d16_hi v238, v6, s[56:59], 0 offen offset:0
    buffer_load_short_d16_hi v240, v6, s[56:59], 0 offen offset:1024
    buffer_load_short_d16_hi v242, v6, s[56:59], 0 offen offset:2048
    buffer_load_short_d16_hi v244, v6, s[56:59], 0 offen offset:3072
    buffer_load_short_d16_hi v246, v6, s[56:59], s93 offen offset:0
    buffer_load_short_d16_hi v248, v6, s[56:59], s93 offen offset:1024
    buffer_load_short_d16_hi v250, v6, s[56:59], s93 offen offset:2048
    v_and_b32 v7, 1, v1
    v_lshlrev_b32 v7, 1, v7
    v_and_b32 v5, 32, v1
    v_lshrrev_b32 v5, 2, v5
    v_or_b32 v7, v7, v5
    v_and_b32 v5, 16, v1
    v_or_b32 v7, v7, v5
    buffer_load_short_d16_hi v252, v7, s[32:35], s77 offen
    v_mov_b32 v7, 0
    buffer_load_short_d16_hi v253, v7, s[72:75], 0 offen
    v_mul_f32 v58, s94, v56
    v_sub_f32 v58, 0, v58
    v_mov_b32 v60, s94
    v_mov_b32 v61, s94
    v_pk_fma_f32 v[8:9], v[8:9], v[60:61], v[58:59] op_sel_hi:[1,1,0]
    v_pk_fma_f32 v[10:11], v[10:11], v[60:61], v[58:59] op_sel_hi:[1,1,0]
    v_exp_f32 v8, v8
    v_exp_f32 v9, v9
    v_exp_f32 v10, v10
    v_exp_f32 v11, v11
    v_mov_b32 v62, v8
    v_mov_b32 v63, v9
    v_cvt_pk_bf16_f32 v40, v8, v9
    v_pk_add_f32 v[62:63], v[62:63], v[10:11]
    v_cvt_pk_bf16_f32 v41, v10, v11
    v_pk_fma_f32 v[12:13], v[12:13], v[60:61], v[58:59] op_sel_hi:[1,1,0]
    v_pk_fma_f32 v[14:15], v[14:15], v[60:61], v[58:59] op_sel_hi:[1,1,0]
    v_exp_f32 v12, v12
    v_exp_f32 v13, v13
    v_exp_f32 v14, v14
    v_exp_f32 v15, v15
    v_pk_add_f32 v[62:63], v[62:63], v[12:13]
    v_cvt_pk_bf16_f32 v42, v12, v13
    v_pk_add_f32 v[62:63], v[62:63], v[14:15]
    v_cvt_pk_bf16_f32 v43, v14, v15
    v_pk_fma_f32 v[16:17], v[16:17], v[60:61], v[58:59] op_sel_hi:[1,1,0]
    v_pk_fma_f32 v[18:19], v[18:19], v[60:61], v[58:59] op_sel_hi:[1,1,0]
    v_exp_f32 v16, v16
    v_exp_f32 v17, v17
    v_exp_f32 v18, v18
    v_exp_f32 v19, v19
    v_pk_add_f32 v[62:63], v[62:63], v[16:17]
    v_cvt_pk_bf16_f32 v44, v16, v17
    v_pk_add_f32 v[62:63], v[62:63], v[18:19]
    v_cvt_pk_bf16_f32 v45, v18, v19
    s_waitcnt vmcnt(32)
    buffer_load_dwordx4 v[108:111], v3, s[40:43], s81 offen offset:3072 nt
    v_pk_fma_f32 v[20:21], v[20:21], v[60:61], v[58:59] op_sel_hi:[1,1,0]
    v_pk_fma_f32 v[22:23], v[22:23], v[60:61], v[58:59] op_sel_hi:[1,1,0]
    v_exp_f32 v20, v20
    v_exp_f32 v21, v21
    v_exp_f32 v22, v22
    v_exp_f32 v23, v23
    v_pk_add_f32 v[62:63], v[62:63], v[20:21]
    v_cvt_pk_bf16_f32 v46, v20, v21
    v_pk_add_f32 v[62:63], v[62:63], v[22:23]
    v_cvt_pk_bf16_f32 v47, v22, v23
    v_pk_fma_f32 v[24:25], v[24:25], v[60:61], v[58:59] op_sel_hi:[1,1,0]
    v_pk_fma_f32 v[26:27], v[26:27], v[60:61], v[58:59] op_sel_hi:[1,1,0]
    v_exp_f32 v24, v24
    v_exp_f32 v25, v25
    v_exp_f32 v26, v26
    v_exp_f32 v27, v27
    v_pk_add_f32 v[62:63], v[62:63], v[24:25]
    v_cvt_pk_bf16_f32 v48, v24, v25
    v_pk_add_f32 v[62:63], v[62:63], v[26:27]
    v_cvt_pk_bf16_f32 v49, v26, v27
    v_pk_fma_f32 v[28:29], v[28:29], v[60:61], v[58:59] op_sel_hi:[1,1,0]
    v_pk_fma_f32 v[30:31], v[30:31], v[60:61], v[58:59] op_sel_hi:[1,1,0]
    v_exp_f32 v28, v28
    v_exp_f32 v29, v29
    v_exp_f32 v30, v30
    v_exp_f32 v31, v31
    v_pk_add_f32 v[62:63], v[62:63], v[28:29]
    v_cvt_pk_bf16_f32 v50, v28, v29
    v_pk_add_f32 v[62:63], v[62:63], v[30:31]
    v_cvt_pk_bf16_f32 v51, v30, v31
    s_waitcnt vmcnt(32)
    s_add_u32 s81, s81, 4096
    buffer_load_dwordx4 v[112:115], v3, s[40:43], s81 offen offset:0 nt
    v_pk_fma_f32 v[32:33], v[32:33], v[60:61], v[58:59] op_sel_hi:[1,1,0]
    v_pk_fma_f32 v[34:35], v[34:35], v[60:61], v[58:59] op_sel_hi:[1,1,0]
    v_exp_f32 v32, v32
    v_exp_f32 v33, v33
    v_exp_f32 v34, v34
    v_exp_f32 v35, v35
    v_pk_add_f32 v[62:63], v[62:63], v[32:33]
    v_cvt_pk_bf16_f32 v52, v32, v33
    v_pk_add_f32 v[62:63], v[62:63], v[34:35]
    v_cvt_pk_bf16_f32 v53, v34, v35
    v_pk_fma_f32 v[36:37], v[36:37], v[60:61], v[58:59] op_sel_hi:[1,1,0]
    v_pk_fma_f32 v[38:39], v[38:39], v[60:61], v[58:59] op_sel_hi:[1,1,0]
    v_exp_f32 v36, v36
    v_exp_f32 v37, v37
    v_exp_f32 v38, v38
    v_exp_f32 v39, v39
    v_pk_add_f32 v[62:63], v[62:63], v[36:37]
    v_cvt_pk_bf16_f32 v54, v36, v37
    v_pk_add_f32 v[62:63], v[62:63], v[38:39]
    v_cvt_pk_bf16_f32 v55, v38, v39
    v_add_f32 v62, v62, v63
    v_mov_b32 v63, v62
    s_nop 1
    v_permlane16_swap_b32 v62, v63
    v_add_f32 v62, v62, v63
    v_mov_b32 v63, v62
    s_nop 1
    v_permlane32_swap_b32 v62, v63
    v_add_f32 v62, v62, v63
    s_mov_b64 exec, 0xff
    ds_write_b32 v4, v62 offset:3584
    s_mov_b64 exec, 1
    v_mov_b32 v5, 0
    v_mov_b32 v6, 1
    ds_add_u32 v5, v6 offset:516
    s_mov_b64 exec, -1
    s_waitcnt vmcnt(32)
    buffer_load_dwordx4 v[116:119], v3, s[40:43], s81 offen offset:1024 nt
    s_waitcnt vmcnt(32)
    buffer_load_dwordx4 v[120:123], v3, s[40:43], s81 offen offset:2048 nt
    s_waitcnt vmcnt(32)
    buffer_load_dwordx4 v[124:127], v3, s[40:43], s81 offen offset:3072 nt
    s_waitcnt vmcnt(32)
    s_add_u32 s81, s81, 4096
    buffer_load_dwordx4 v[128:131], v3, s[40:43], s81 offen offset:0 nt
    s_waitcnt vmcnt(32)
    buffer_load_dwordx4 v[132:135], v3, s[40:43], s81 offen offset:1024 nt
    v_perm_b32 v56, v68, v64, s89
    v_perm_b32 v57, v76, v72, s89
    v_perm_b32 v58, v84, v80, s89
    v_perm_b32 v59, v92, v88, s89
    v_perm_b32 v60, v68, v64, s90
    v_perm_b32 v61, v76, v72, s90
    v_perm_b32 v62, v84, v80, s90
    v_perm_b32 v63, v92, v88, s90
    v_mfma_f32_16x16x32_bf16 v[8:11], v[56:59], v[40:43], 0
    v_perm_b32 v56, v69, v65, s89
    v_perm_b32 v57, v77, v73, s89
    v_perm_b32 v58, v85, v81, s89
    v_perm_b32 v59, v93, v89, s89
    v_mfma_f32_16x16x32_bf16 v[12:15], v[60:63], v[40:43], 0
    v_perm_b32 v60, v69, v65, s90
    v_perm_b32 v61, v77, v73, s90
    v_perm_b32 v62, v85, v81, s90
    v_perm_b32 v63, v93, v89, s90
    v_mfma_f32_16x16x32_bf16 v[16:19], v[56:59], v[40:43], 0
    v_perm_b32 v56, v70, v66, s89
    v_perm_b32 v57, v78, v74, s89
    v_perm_b32 v58, v86, v82, s89
    v_perm_b32 v59, v94, v90, s89
    v_mfma_f32_16x16x32_bf16 v[20:23], v[60:63], v[40:43], 0
    v_perm_b32 v60, v70, v66, s90
    v_perm_b32 v61, v78, v74, s90
    v_perm_b32 v62, v86, v82, s90
    v_perm_b32 v63, v94, v90, s90
    v_mfma_f32_16x16x32_bf16 v[24:27], v[56:59], v[40:43], 0
    v_perm_b32 v56, v71, v67, s89
    v_perm_b32 v57, v79, v75, s89
    v_perm_b32 v58, v87, v83, s89
    v_perm_b32 v59, v95, v91, s89
    v_mfma_f32_16x16x32_bf16 v[28:31], v[60:63], v[40:43], 0
    v_perm_b32 v60, v71, v67, s90
    v_perm_b32 v61, v79, v75, s90
    v_perm_b32 v62, v87, v83, s90
    v_perm_b32 v63, v95, v91, s90
    v_mfma_f32_16x16x32_bf16 v[32:35], v[56:59], v[40:43], 0
    s_nop 0
    v_mfma_f32_16x16x32_bf16 v[36:39], v[60:63], v[40:43], 0
    s_waitcnt vmcnt(32)
    buffer_load_dwordx4 v[136:139], v3, s[40:43], s81 offen offset:2048 nt
    s_waitcnt vmcnt(32)
    buffer_load_dwordx4 v[140:143], v3, s[40:43], s81 offen offset:3072 nt
    s_waitcnt vmcnt(32)
    s_add_u32 s81, s81, 4096
    buffer_load_dwordx4 v[144:147], v3, s[40:43], s81 offen offset:0 nt
    s_waitcnt vmcnt(9)
    buffer_load_dwordx4 v[148:151], v3, s[40:43], s81 offen offset:1024 nt
    v_mul_f32 v239, v238, v225
    v_mul_f32 v225, v224, v225
    v_mul_f32 v241, v240, v227
    v_mul_f32 v227, v226, v227
    v_mul_f32 v243, v242, v229
    v_mul_f32 v229, v228, v229
    v_mul_f32 v245, v244, v231
    v_mul_f32 v231, v230, v231
    v_mul_f32 v247, v246, v233
    v_mul_f32 v233, v232, v233
    v_mul_f32 v249, v248, v235
    v_mul_f32 v235, v234, v235
    v_mul_f32 v251, v250, v237
    v_mul_f32 v237, v236, v237
    s_waitcnt vmcnt(9)
    buffer_load_dwordx4 v[152:155], v3, s[40:43], s81 offen offset:2048 nt
    s_waitcnt vmcnt(9)
    buffer_load_dwordx4 v[156:159], v3, s[40:43], s81 offen offset:3072 nt
    s_waitcnt vmcnt(9)
    s_add_u32 s81, s81, 4096
    buffer_load_dwordx4 v[160:163], v3, s[40:43], s81 offen offset:0 nt
    s_waitcnt vmcnt(9)
    buffer_load_dwordx4 v[164:167], v3, s[40:43], s81 offen offset:1024 nt
    v_perm_b32 v56, v100, v96, s89
    v_perm_b32 v57, v108, v104, s89
    v_perm_b32 v58, v116, v112, s89
    v_perm_b32 v59, v124, v120, s89
    v_perm_b32 v60, v100, v96, s90
    v_perm_b32 v61, v108, v104, s90
    v_perm_b32 v62, v116, v112, s90
    v_perm_b32 v63, v124, v120, s90
    v_mfma_f32_16x16x32_bf16 v[8:11], v[56:59], v[44:47], v[8:11]
    v_perm_b32 v56, v101, v97, s89
    v_perm_b32 v57, v109, v105, s89
    v_perm_b32 v58, v117, v113, s89
    v_perm_b32 v59, v125, v121, s89
    v_mfma_f32_16x16x32_bf16 v[12:15], v[60:63], v[44:47], v[12:15]
    v_perm_b32 v60, v101, v97, s90
    v_perm_b32 v61, v109, v105, s90
    v_perm_b32 v62, v117, v113, s90
    v_perm_b32 v63, v125, v121, s90
    v_mfma_f32_16x16x32_bf16 v[16:19], v[56:59], v[44:47], v[16:19]
    v_perm_b32 v56, v102, v98, s89
    v_perm_b32 v57, v110, v106, s89
    v_perm_b32 v58, v118, v114, s89
    v_perm_b32 v59, v126, v122, s89
    v_mfma_f32_16x16x32_bf16 v[20:23], v[60:63], v[44:47], v[20:23]
    v_perm_b32 v60, v102, v98, s90
    v_perm_b32 v61, v110, v106, s90
    v_perm_b32 v62, v118, v114, s90
    v_perm_b32 v63, v126, v122, s90
    v_mfma_f32_16x16x32_bf16 v[24:27], v[56:59], v[44:47], v[24:27]
    v_perm_b32 v56, v103, v99, s89
    v_perm_b32 v57, v111, v107, s89
    v_perm_b32 v58, v119, v115, s89
    v_perm_b32 v59, v127, v123, s89
    v_mfma_f32_16x16x32_bf16 v[28:31], v[60:63], v[44:47], v[28:31]
    v_perm_b32 v60, v103, v99, s90
    v_perm_b32 v61, v111, v107, s90
    v_perm_b32 v62, v119, v115, s90
    v_perm_b32 v63, v127, v123, s90
    v_mfma_f32_16x16x32_bf16 v[32:35], v[56:59], v[44:47], v[32:35]
    s_nop 0
    v_mfma_f32_16x16x32_bf16 v[36:39], v[60:63], v[44:47], v[36:39]
    s_waitcnt vmcnt(9)
    buffer_load_dwordx4 v[168:171], v3, s[40:43], s81 offen offset:2048 nt
    s_waitcnt vmcnt(9)
    buffer_load_dwordx4 v[172:175], v3, s[40:43], s81 offen offset:3072 nt
    s_waitcnt vmcnt(9)
    s_add_u32 s81, s81, 4096
    buffer_load_dwordx4 v[176:179], v3, s[40:43], s81 offen offset:0 nt
    s_waitcnt vmcnt(9)
    buffer_load_dwordx4 v[180:183], v3, s[40:43], s81 offen offset:1024 nt
    s_waitcnt vmcnt(9)
    buffer_load_dwordx4 v[184:187], v3, s[40:43], s81 offen offset:2048 nt
    s_waitcnt vmcnt(9)
    buffer_load_dwordx4 v[188:191], v3, s[40:43], s81 offen offset:3072 nt
    s_waitcnt vmcnt(8)
    v_perm_b32 v56, v132, v128, s89
    v_perm_b32 v57, v140, v136, s89
    v_perm_b32 v58, v148, v144, s89
    v_perm_b32 v59, v156, v152, s89
    v_perm_b32 v60, v132, v128, s90
    v_perm_b32 v61, v140, v136, s90
    v_perm_b32 v62, v148, v144, s90
    v_perm_b32 v63, v156, v152, s90
    v_mfma_f32_16x16x32_bf16 v[8:11], v[56:59], v[48:51], v[8:11]
    v_perm_b32 v56, v133, v129, s89
    v_perm_b32 v57, v141, v137, s89
    v_perm_b32 v58, v149, v145, s89
    v_perm_b32 v59, v157, v153, s89
    v_mfma_f32_16x16x32_bf16 v[12:15], v[60:63], v[48:51], v[12:15]
    v_perm_b32 v60, v133, v129, s90
    v_perm_b32 v61, v141, v137, s90
    v_perm_b32 v62, v149, v145, s90
    v_perm_b32 v63, v157, v153, s90
    v_mfma_f32_16x16x32_bf16 v[16:19], v[56:59], v[48:51], v[16:19]
    v_perm_b32 v56, v134, v130, s89
    v_perm_b32 v57, v142, v138, s89
    v_perm_b32 v58, v150, v146, s89
    v_perm_b32 v59, v158, v154, s89
    v_mfma_f32_16x16x32_bf16 v[20:23], v[60:63], v[48:51], v[20:23]
    v_perm_b32 v60, v134, v130, s90
    v_perm_b32 v61, v142, v138, s90
    v_perm_b32 v62, v150, v146, s90
    v_perm_b32 v63, v158, v154, s90
    v_mfma_f32_16x16x32_bf16 v[24:27], v[56:59], v[48:51], v[24:27]
    v_perm_b32 v56, v135, v131, s89
    v_perm_b32 v57, v143, v139, s89
    v_perm_b32 v58, v151, v147, s89
    v_perm_b32 v59, v159, v155, s89
    v_mfma_f32_16x16x32_bf16 v[28:31], v[60:63], v[48:51], v[28:31]
    v_perm_b32 v60, v135, v131, s90
    v_perm_b32 v61, v143, v139, s90
    v_perm_b32 v62, v151, v147, s90
    v_perm_b32 v63, v159, v155, s90
    v_mfma_f32_16x16x32_bf16 v[32:35], v[56:59], v[48:51], v[32:35]
    s_nop 0
    v_mfma_f32_16x16x32_bf16 v[36:39], v[60:63], v[48:51], v[36:39]
    v_mov_b32 v5, 0
    s_mov_b32 s93, 0
L_cm_poll:
    ds_read_b32 v6, v5 offset:516
    s_waitcnt lgkmcnt(0)
    v_readfirstlane_b32 s82, v6
    s_add_u32 s93, s93, 1
    s_cmp_ge_u32 s82, 8
    s_cbranch_scc1 L_cm_ok
    s_sleep 1
    s_cmp_lt_u32 s93, 160000
    s_cbranch_scc1 L_cm_poll
L_cm_ok:
    v_and_b32 v5, 7, v1
    v_lshlrev_b32 v5, 5, v5
    s_lshl_b32 s82, s3, 2
    v_add_u32 v4, s82, v5
    ds_read_b128 v[64:67], v5 offset:3328
    ds_read_b128 v[68:71], v5 offset:3344
    ds_read_b32 v72, v4 offset:3328
    v_lshrrev_b32 v6, 3, v1
    v_lshl_add_u32 v6, v6, 2, v5
    ds_read_b32 v74, v6 offset:3328
    ds_read_b32 v75, v6 offset:3584
    s_waitcnt lgkmcnt(0)
    v_max3_f32 v64, v64, v65, v66
    v_max3_f32 v68, v68, v69, v70
    v_max3_f32 v64, v64, v67, v71
    v_max_f32 v64, v64, v68
    v_sub_f32 v72, v72, v64
    v_sub_f32 v74, v74, v64
    v_mul_f32 v72, s94, v72
    v_mul_f32 v74, s94, v74
    v_exp_f32 v72, v72
    v_exp_f32 v74, v74
    s_nop 0
    v_mul_f32 v77, v75, v74
    v_mov_b32 v76, v64
    s_nop 0
    v_add_f32_dpp v77, v77, v77 row_ror:8 row_mask:0xf bank_mask:0xf
    v_mov_b32 v78, s76
    v_mov_b32 v79, v77
    s_nop 1
    v_permlane16_swap_b32 v77, v79
    v_add_f32 v77, v77, v79
    v_mov_b32 v79, v77
    s_nop 1
    v_permlane32_swap_b32 v77, v79
    v_add_f32 v77, v77, v79
    v_mov_b32 v79, s76
    v_bfe_u32 v7, v0, 5, 3
    v_lshlrev_b32 v7, 5, v7
    ds_read_b128 v[80:83], v7 offset:3328
    ds_read_b128 v[84:87], v7 offset:3344
    v_mov_b32 v90, s94
    s_waitcnt lgkmcnt(0)
    v_max3_f32 v88, v80, v81, v82
    v_max3_f32 v89, v84, v85, v86
    v_max3_f32 v88, v88, v83, v87
    v_max_f32 v88, v88, v89
    v_pk_add_f32 v[80:81], v[80:81], v[88:89] op_sel_hi:[1,0] neg_lo:[0,1] neg_hi:[0,1]
    v_pk_add_f32 v[82:83], v[82:83], v[88:89] op_sel_hi:[1,0] neg_lo:[0,1] neg_hi:[0,1]
    v_pk_add_f32 v[84:85], v[84:85], v[88:89] op_sel_hi:[1,0] neg_lo:[0,1] neg_hi:[0,1]
    v_pk_add_f32 v[86:87], v[86:87], v[88:89] op_sel_hi:[1,0] neg_lo:[0,1] neg_hi:[0,1]
    v_pk_mul_f32 v[80:81], v[80:81], v[90:91] op_sel_hi:[1,0]
    v_pk_mul_f32 v[82:83], v[82:83], v[90:91] op_sel_hi:[1,0]
    v_pk_mul_f32 v[84:85], v[84:85], v[90:91] op_sel_hi:[1,0]
    v_pk_mul_f32 v[86:87], v[86:87], v[90:91] op_sel_hi:[1,0]
    v_exp_f32 v80, v80
    v_exp_f32 v81, v81
    v_exp_f32 v82, v82
    v_exp_f32 v83, v83
    v_exp_f32 v84, v84
    v_exp_f32 v85, v85
    v_exp_f32 v86, v86
    v_exp_f32 v87, v87
    v_and_b32 v4, 15, v1
    v_mul_u32_u24 v4, 528, v4
    v_lshrrev_b32 v5, 4, v1
    v_lshlrev_b32 v5, 7, v5
    v_add_u32 v4, v4, v5
    s_mul_i32 s82, s3, 4224
    v_add_u32 v4, s82, v4
    v_and_b32 v7, 255, v0
    v_lshrrev_b32 v5, 5, v7
    v_add_u32 v5, v5, v7
    v_lshlrev_b32 v5, 4, v5
    v_lshrrev_b32 v6, 3, v7
    v_mul_u32_u24 v6, 8192, v6
    v_and_b32 v7, 7, v7
    v_lshlrev_b32 v7, 4, v7
    v_add_u32 v6, v6, v7
    v_mov_b32 v64, s84
    v_mov_b32 v65, s85
    v_mov_b32 v66, s86
    v_mov_b32 v67, s87
    v_bfe_u32 v100, v1, 2, 1
    v_lshlrev_b32 v100, 6, v100
    v_and_b32 v101, 0x30, v1
    v_add_u32 v100, v100, v101
    v_add_u32 v100, 3840, v100
    v_and_b32 v101, 3, v1
    v_mov_b32 v102, 528
    v_cmp_eq_u32 vcc, 0, v101
    s_nop 1
    v_cndmask_b32 v68, v102, v100, vcc
    v_cmp_eq_u32 vcc, 1, v101
    s_nop 1
    v_cndmask_b32 v69, v102, v100, vcc
    v_cmp_eq_u32 vcc, 2, v101
    s_nop 1
    v_cndmask_b32 v70, v102, v100, vcc
    v_cmp_eq_u32 vcc, 3, v101
    s_nop 1
    v_cndmask_b32 v71, v102, v100, vcc
    v_bfe_u32 v73, v1, 2, 1
    v_mul_u32_u24 v73, 4096, v73
    v_lshlrev_b32 v73, 8, v73
    v_lshrrev_b32 v100, 4, v1
    v_mul_u32_u24 v100, 32768, v100
    v_bfe_u32 v101, v1, 1, 1
    v_mul_u32_u24 v101, 8192, v101
    v_add3_u32 v73, v73, v100, v101
    v_and_b32 v100, 1, v1
    v_lshlrev_b32 v100, 4, v100
    v_add_u32 v73, v73, v100
    v_lshlrev_b32 v74, 4, v1
    v_lshrrev_b32 v75, 3, v1
    v_lshlrev_b32 v75, 4, v75
    s_waitcnt vmcnt(6)
    v_perm_b32 v108, v164, v160, s89
    v_perm_b32 v112, v164, v160, s90
    v_perm_b32 v116, v165, v161, s89
    v_perm_b32 v120, v165, v161, s90
    v_perm_b32 v124, v166, v162, s89
    v_perm_b32 v128, v166, v162, s90
    v_perm_b32 v132, v167, v163, s89
    v_perm_b32 v136, v167, v163, s90
    s_waitcnt vmcnt(4)
    v_perm_b32 v109, v172, v168, s89
    v_perm_b32 v113, v172, v168, s90
    v_perm_b32 v117, v173, v169, s89
    v_perm_b32 v121, v173, v169, s90
    v_perm_b32 v125, v174, v170, s89
    v_perm_b32 v129, v174, v170, s90
    v_perm_b32 v133, v175, v171, s89
    v_perm_b32 v137, v175, v171, s90
    s_waitcnt vmcnt(2)
    v_perm_b32 v110, v180, v176, s89
    v_perm_b32 v114, v180, v176, s90
    v_perm_b32 v118, v181, v177, s89
    v_perm_b32 v122, v181, v177, s90
    v_perm_b32 v126, v182, v178, s89
    v_perm_b32 v130, v182, v178, s90
    v_perm_b32 v134, v183, v179, s89
    v_perm_b32 v138, v183, v179, s90
    s_waitcnt vmcnt(0)
    v_perm_b32 v111, v188, v184, s89
    v_perm_b32 v115, v188, v184, s90
    v_perm_b32 v119, v189, v185, s89
    v_mfma_f32_16x16x32_bf16 v[8:11], v[108:111], v[52:55], v[8:11]
    v_perm_b32 v123, v189, v185, s90
    v_mfma_f32_16x16x32_bf16 v[12:15], v[112:115], v[52:55], v[12:15]
    v_perm_b32 v127, v190, v186, s89
    v_mfma_f32_16x16x32_bf16 v[16:19], v[116:119], v[52:55], v[16:19]
    v_perm_b32 v131, v190, v186, s90
    v_mfma_f32_16x16x32_bf16 v[20:23], v[120:123], v[52:55], v[20:23]
    v_perm_b32 v135, v191, v187, s89
    v_mfma_f32_16x16x32_bf16 v[24:27], v[124:127], v[52:55], v[24:27]
    v_perm_b32 v139, v191, v187, s90
    v_mfma_f32_16x16x32_bf16 v[28:31], v[128:131], v[52:55], v[28:31]
    v_mfma_f32_16x16x32_bf16 v[32:35], v[132:135], v[52:55], v[32:35]
    v_mfma_f32_16x16x32_bf16 v[36:39], v[136:139], v[52:55], v[36:39]
    s_cmp_lt_u32 s3, 4
    s_cbranch_scc1 L_woh
    v_lshrrev_b32 v104, 4, v1
    v_lshlrev_b32 v104, 14, v104
    v_and_b32 v105, 15, v1
    v_lshlrev_b32 v105, 3, v105
    v_or_b32 v104, v104, v105
    buffer_load_dwordx2 v[192:193], v104, s[48:51], 0 offen offset:0 nt
    buffer_load_dwordx2 v[194:195], v104, s[48:51], 0 offen offset:2048 nt
    s_mov_b32 s82, 4096
    buffer_load_dwordx2 v[196:197], v104, s[48:51], s82 offen offset:0 nt
    buffer_load_dwordx2 v[198:199], v104, s[48:51], s82 offen offset:2048 nt
    s_mov_b32 s82, 8192
    buffer_load_dwordx2 v[200:201], v104, s[48:51], s82 offen offset:0 nt
    buffer_load_dwordx2 v[202:203], v104, s[48:51], s82 offen offset:2048 nt
    s_mov_b32 s82, 12288
    buffer_load_dwordx2 v[204:205], v104, s[48:51], s82 offen offset:0 nt
    buffer_load_dwordx2 v[206:207], v104, s[48:51], s82 offen offset:2048 nt
L_woh:
    s_mov_b32 exec_lo, 0x00ff00ff
    s_mov_b32 exec_hi, 0x00ff00ff
    ds_write_b128 v4, v[8:11] offset:8192
    ds_write_b128 v4, v[12:15] offset:8208
    ds_write_b128 v4, v[16:19] offset:8224
    ds_write_b128 v4, v[20:23] offset:8240
    ds_write_b128 v4, v[24:27] offset:8256
    ds_write_b128 v4, v[28:31] offset:8272
    ds_write_b128 v4, v[32:35] offset:8288
    ds_write_b128 v4, v[36:39] offset:8304
    s_mov_b64 exec, -1
    s_cmp_lg_u32 s3, 0
    s_cbranch_scc1 L_mlp
    v_lshlrev_b32 v6, 10, v1
    s_mov_b64 exec, 0xff
    buffer_store_dwordx4 v[76:79], v6, s[64:67], s78 offen sc1
    s_mov_b64 exec, -1
L_mlp:
    s_cmp_gt_u32 s3, 3
    s_cbranch_scc1 L_wol
    v_lshrrev_b32 v78, 4, v1
    v_lshlrev_b32 v78, 14, v78
    v_and_b32 v79, 15, v1
    v_lshlrev_b32 v79, 3, v79
    v_or_b32 v78, v78, v79
    buffer_load_dwordx2 v[192:193], v78, s[48:51], 0 offen offset:0 nt
    buffer_load_dwordx2 v[194:195], v78, s[48:51], 0 offen offset:2048 nt
    s_mov_b32 s82, 4096
    buffer_load_dwordx2 v[196:197], v78, s[48:51], s82 offen offset:0 nt
    buffer_load_dwordx2 v[198:199], v78, s[48:51], s82 offen offset:2048 nt
    s_mov_b32 s82, 8192
    buffer_load_dwordx2 v[200:201], v78, s[48:51], s82 offen offset:0 nt
    buffer_load_dwordx2 v[202:203], v78, s[48:51], s82 offen offset:2048 nt
    s_mov_b32 s82, 12288
    buffer_load_dwordx2 v[204:205], v78, s[48:51], s82 offen offset:0 nt
    buffer_load_dwordx2 v[206:207], v78, s[48:51], s82 offen offset:2048 nt
L_wol:
    s_waitcnt lgkmcnt(0)
    s_barrier
    s_cmp_lt_u32 s3, 2
    s_cbranch_scc1 L_h1
    s_cmp_lt_u32 s3, 4
    s_cbranch_scc1 L_wowait
    ds_read_b128 v[8:11], v5 offset:8192
    ds_read_b128 v[12:15], v5 offset:12416
    ds_read_b128 v[16:19], v5 offset:16640
    ds_read_b128 v[20:23], v5 offset:20864
    ds_read_b128 v[24:27], v5 offset:25088
    ds_read_b128 v[28:31], v5 offset:29312
    ds_read_b128 v[32:35], v5 offset:33536
    ds_read_b128 v[36:39], v5 offset:37760
    s_waitcnt lgkmcnt(6)
    v_pk_mul_f32 v[8:9], v[8:9], v[80:81] op_sel:[0,0] op_sel_hi:[1,0]
    v_pk_mul_f32 v[10:11], v[10:11], v[80:81] op_sel:[0,0] op_sel_hi:[1,0]
    v_pk_mul_f32 v[12:13], v[12:13], v[80:81] op_sel:[0,1] op_sel_hi:[1,1]
    v_pk_mul_f32 v[14:15], v[14:15], v[80:81] op_sel:[0,1] op_sel_hi:[1,1]
    s_waitcnt lgkmcnt(4)
    v_pk_fma_f32 v[8:9], v[16:17], v[82:83], v[8:9] op_sel:[0,0,0] op_sel_hi:[1,0,1]
    v_pk_fma_f32 v[10:11], v[18:19], v[82:83], v[10:11] op_sel:[0,0,0] op_sel_hi:[1,0,1]
    v_pk_fma_f32 v[12:13], v[20:21], v[82:83], v[12:13] op_sel:[0,1,0] op_sel_hi:[1,1,1]
    v_pk_fma_f32 v[14:15], v[22:23], v[82:83], v[14:15] op_sel:[0,1,0] op_sel_hi:[1,1,1]
    s_waitcnt lgkmcnt(2)
    v_pk_fma_f32 v[8:9], v[24:25], v[84:85], v[8:9] op_sel:[0,0,0] op_sel_hi:[1,0,1]
    v_pk_fma_f32 v[10:11], v[26:27], v[84:85], v[10:11] op_sel:[0,0,0] op_sel_hi:[1,0,1]
    v_pk_fma_f32 v[12:13], v[28:29], v[84:85], v[12:13] op_sel:[0,1,0] op_sel_hi:[1,1,1]
    v_pk_fma_f32 v[14:15], v[30:31], v[84:85], v[14:15] op_sel:[0,1,0] op_sel_hi:[1,1,1]
    s_waitcnt lgkmcnt(0)
    v_pk_fma_f32 v[8:9], v[32:33], v[86:87], v[8:9] op_sel:[0,0,0] op_sel_hi:[1,0,1]
    v_pk_fma_f32 v[10:11], v[34:35], v[86:87], v[10:11] op_sel:[0,0,0] op_sel_hi:[1,0,1]
    v_pk_fma_f32 v[12:13], v[36:37], v[86:87], v[12:13] op_sel:[0,1,0] op_sel_hi:[1,1,1]
    v_pk_fma_f32 v[14:15], v[38:39], v[86:87], v[14:15] op_sel:[0,1,0] op_sel_hi:[1,1,1]
    v_pk_add_f32 v[8:9], v[8:9], v[12:13]
    v_pk_add_f32 v[10:11], v[10:11], v[14:15]
    v_and_or_b32 v8, v8, s91, v64
    v_and_or_b32 v9, v9, s91, v65
    v_and_or_b32 v10, v10, s91, v66
    v_and_or_b32 v11, v11, s91, v67
    buffer_store_dwordx4 v[8:11], v6, s[64:67], s96 offen sc1
    s_waitcnt vmcnt(0)
    s_branch L_wowait
L_h1:
    buffer_load_dwordx4 v[80:83], v75, s[64:67], s79 offen offset:0 sc1
    buffer_load_dwordx4 v[84:87], v75, s[64:67], s79 offen offset:128 sc1
    buffer_load_dwordx4 v[88:91], v75, s[64:67], s79 offen offset:256 sc1
    buffer_load_dwordx4 v[92:95], v75, s[64:67], s79 offen offset:384 sc1
    buffer_load_dwordx4 v[8:11], v74, s[64:67], s97 offen offset:0 sc1
    buffer_load_dwordx4 v[12:15], v74, s[64:67], s97 offen offset:1024 sc1
    buffer_load_dwordx4 v[16:19], v74, s[64:67], s97 offen offset:2048 sc1
    buffer_load_dwordx4 v[20:23], v74, s[64:67], s97 offen offset:3072 sc1
    s_mov_b32 s93, 0
    s_waitcnt vmcnt(4)
    v_xor_b32 v100, s76, v82
    v_xor_b32 v101, s76, v86
    v_xor_b32 v102, s76, v90
    v_xor_b32 v103, s76, v94
    v_or3_b32 v100, v100, v101, v102
    v_or_b32 v100, v100, v103
    v_cmp_ne_u32 vcc, 0, v100
    s_cbranch_vccnz L_mlretry
L_mlok:
    v_max3_f32 v100, v80, v84, v88
    v_max_f32 v100, v100, v92
    s_nop 1
    v_max_f32_dpp v100, v100, v100 row_ror:8 row_mask:0xf bank_mask:0xf
    v_mov_b32 v101, v100
    s_nop 1
    v_permlane16_swap_b32 v100, v101
    v_max_f32 v100, v100, v101
    v_mov_b32 v101, v100
    s_nop 1
    v_permlane32_swap_b32 v100, v101
    v_max_f32 v100, v100, v101
    v_sub_f32 v96, v80, v100
    v_sub_f32 v97, v84, v100
    v_sub_f32 v98, v88, v100
    v_sub_f32 v99, v92, v100
    v_mul_f32 v96, s94, v96
    v_mul_f32 v97, s94, v97
    v_mul_f32 v98, s94, v98
    v_mul_f32 v99, s94, v99
    v_exp_f32 v96, v96
    v_exp_f32 v97, v97
    v_exp_f32 v98, v98
    v_exp_f32 v99, v99
    v_mul_f32 v100, v96, v81
    v_mul_f32 v101, v97, v85
    v_fma_f32 v100, v98, v89, v100
    v_fma_f32 v101, v99, v93, v101
    v_add_f32 v100, v100, v101
    s_nop 1
    v_add_f32_dpp v100, v100, v100 row_ror:8 row_mask:0xf bank_mask:0xf
    v_mov_b32 v101, v100
    s_nop 1
    v_permlane16_swap_b32 v100, v101
    v_add_f32 v100, v100, v101
    v_mov_b32 v101, v100
    s_nop 1
    v_permlane32_swap_b32 v100, v101
    v_add_f32 v100, v100, v101
    v_rcp_f32 v100, v100
    s_nop 0
    v_mul_f32 v96, v96, v100
    v_mul_f32 v97, v97, v100
    v_mul_f32 v98, v98, v100
    v_mul_f32 v99, v99, v100
    v_and_b32 v4, 7, v1
    v_lshlrev_b32 v4, 1, v4
    v_bfe_u32 v5, v1, 4, 1
    v_lshl_or_b32 v4, v5, 5, v4
    v_lshrrev_b32 v5, 5, v1
    v_lshl_or_b32 v4, v5, 4, v4
    s_lshl_b32 s82, s3, 6
    v_add_u32 v4, s82, v4
    v_perm_b32 v208, v194, v192, s89
    v_perm_b32 v209, v198, v196, s89
    v_perm_b32 v210, v202, v200, s89
    v_perm_b32 v211, v206, v204, s89
    v_perm_b32 v212, v194, v192, s90
    v_perm_b32 v213, v198, v196, s90
    v_perm_b32 v214, v202, v200, s90
    v_perm_b32 v215, v206, v204, s90
    v_perm_b32 v216, v195, v193, s89
    v_perm_b32 v217, v199, v197, s89
    v_perm_b32 v218, v203, v201, s89
    v_perm_b32 v219, v207, v205, s89
    v_perm_b32 v220, v195, v193, s90
    v_perm_b32 v221, v199, v197, s90
    v_perm_b32 v222, v203, v201, s90
    v_perm_b32 v223, v207, v205, s90
    s_branch L_h1_chk
L_h1_poll:
    buffer_load_dwordx4 v[8:11], v74, s[64:67], s97 offen offset:0 sc1
    buffer_load_dwordx4 v[12:15], v74, s[64:67], s97 offen offset:1024 sc1
    buffer_load_dwordx4 v[16:19], v74, s[64:67], s97 offen offset:2048 sc1
    buffer_load_dwordx4 v[20:23], v74, s[64:67], s97 offen offset:3072 sc1
L_h1_chk:
    s_waitcnt vmcnt(0)
    v_xor_b32 v8, s84, v8
    v_xor_b32 v9, s85, v9
    v_xor_b32 v10, s86, v10
    v_xor_b32 v11, s87, v11
    v_xor_b32 v12, s84, v12
    v_xor_b32 v13, s85, v13
    v_xor_b32 v14, s86, v14
    v_xor_b32 v15, s87, v15
    v_xor_b32 v16, s84, v16
    v_xor_b32 v17, s85, v17
    v_xor_b32 v18, s86, v18
    v_xor_b32 v19, s87, v19
    v_xor_b32 v20, s84, v20
    v_xor_b32 v21, s85, v21
    v_xor_b32 v22, s86, v22
    v_xor_b32 v23, s87, v23
    v_or3_b32 v24, v8, v9, v10
    v_or3_b32 v25, v12, v13, v14
    v_or3_b32 v26, v16, v17, v18
    v_or3_b32 v27, v20, v21, v22
    v_or3_b32 v24, v24, v11, v15
    v_or3_b32 v25, v25, v19, v23
    v_or3_b32 v24, v24, v26, v27
    v_or_b32 v24, v24, v25
    v_and_b32 v24, 0x3ff, v24
    v_cmp_ne_u32 vcc, 0, v24
    s_cbranch_vccz L_h1_ok
    s_mov_b64 exec, vcc
    s_sleep 1
    s_add_u32 s93, s93, 1
    s_cmp_lt_u32 s93, 20000
    s_cbranch_scc1 L_h1_poll
L_h1_ok:
    s_mov_b64 exec, -1
    v_pk_mul_f32 v[24:25], v[8:9], v[96:97] op_sel_hi:[1,0]
    v_pk_mul_f32 v[26:27], v[10:11], v[96:97] op_sel_hi:[1,0]
    v_pk_mul_f32 v[28:29], v[16:17], v[98:99] op_sel_hi:[1,0]
    v_pk_mul_f32 v[30:31], v[18:19], v[98:99] op_sel_hi:[1,0]
    v_pk_fma_f32 v[24:25], v[12:13], v[96:97], v[24:25] op_sel:[0,1,0] op_sel_hi:[1,1,1]
    v_pk_fma_f32 v[26:27], v[14:15], v[96:97], v[26:27] op_sel:[0,1,0] op_sel_hi:[1,1,1]
    v_pk_fma_f32 v[28:29], v[20:21], v[98:99], v[28:29] op_sel:[0,1,0] op_sel_hi:[1,1,1]
    v_pk_fma_f32 v[30:31], v[22:23], v[98:99], v[30:31] op_sel:[0,1,0] op_sel_hi:[1,1,1]
    v_pk_add_f32 v[24:25], v[24:25], v[28:29]
    v_pk_add_f32 v[26:27], v[26:27], v[30:31]
    s_nop 0
    v_permlane32_swap_b32 v24, v25
    v_permlane32_swap_b32 v26, v27
    v_add_f32 v24, v24, v25
    v_add_f32 v26, v26, v27
    s_nop 1
    v_permlane16_swap_b32 v24, v26
    v_add_f32 v24, v24, v26
    s_nop 1
    v_add_f32_dpp v24, v24, v24 row_ror:8 row_mask:0xf bank_mask:0xf
    v_cvt_pk_bf16_f32 v24, v24, v24
    s_mov_b32 exec_lo, 0x00ff00ff
    s_mov_b32 exec_hi, 0x00ff00ff
    ds_write_b16 v4, v24 offset:3840
    s_mov_b64 exec, -1
    s_branch L_permdone
L_wowait:
    s_waitcnt vmcnt(0)
L_wogot:
    v_perm_b32 v208, v194, v192, s89
    v_perm_b32 v209, v198, v196, s89
    v_perm_b32 v210, v202, v200, s89
    v_perm_b32 v211, v206, v204, s89
    v_perm_b32 v212, v194, v192, s90
    v_perm_b32 v213, v198, v196, s90
    v_perm_b32 v214, v202, v200, s90
    v_perm_b32 v215, v206, v204, s90
    v_perm_b32 v216, v195, v193, s89
    v_perm_b32 v217, v199, v197, s89
    v_perm_b32 v218, v203, v201, s89
    v_perm_b32 v219, v207, v205, s89
    v_perm_b32 v220, v195, v193, s90
    v_perm_b32 v221, v199, v197, s90
    v_perm_b32 v222, v203, v201, s90
    v_perm_b32 v223, v207, v205, s90
L_permdone:
    s_waitcnt lgkmcnt(0)
    s_barrier
    ds_read_b128 v[12:15], v68
    ds_read_b128 v[16:19], v69
    ds_read_b128 v[20:23], v70
    ds_read_b128 v[24:27], v71
    s_waitcnt lgkmcnt(3)
    v_mfma_f32_16x16x32_bf16 v[28:31], v[208:211], v[12:15], 0
    s_waitcnt lgkmcnt(2)
    v_mfma_f32_16x16x32_bf16 v[28:31], v[212:215], v[16:19], v[28:31]
    s_waitcnt lgkmcnt(1)
    v_mfma_f32_16x16x32_bf16 v[28:31], v[216:219], v[20:23], v[28:31]
    s_waitcnt lgkmcnt(0)
    v_mfma_f32_16x16x32_bf16 v[28:31], v[220:223], v[24:27], v[28:31]
    s_nop 7
    v_and_or_b32 v28, v28, s91, v64
    v_and_or_b32 v29, v29, s91, v65
    v_and_or_b32 v30, v30, s91, v66
    v_and_or_b32 v31, v31, s91, v67
    s_mov_b32 exec_lo, 0x00ff00ff
    s_mov_b32 exec_hi, 0x00ff00ff
    buffer_store_dwordx4 v[28:31], v73, s[64:67], s98 offen sc1
    s_mov_b64 exec, -1
    s_nop 0
    v_mov_b32 v30, 0xbdd2d3e8
    v_mov_b32 v31, 0xc0135761
    v_mul_f32 v29, 0x40400000, v30
    v_mul_f32 v20, v224, v224
    v_mul_f32 v21, v238, v238
    v_mul_f32 v22, v30, v20
    v_mul_f32 v23, v29, v20
    v_fma_f32 v24, v21, v30, v31
    v_fma_f32 v25, v21, v29, v31
    v_mul_f32 v150, v22, v224
    v_mul_f32 v151, v23, v238
    v_mul_f32 v164, v25, v224
    v_mul_f32 v165, v24, v238
    v_mul_f32 v20, v226, v226
    v_mul_f32 v21, v240, v240
    v_mul_f32 v22, v30, v20
    v_mul_f32 v23, v29, v20
    v_fma_f32 v24, v21, v30, v31
    v_fma_f32 v25, v21, v29, v31
    v_mul_f32 v152, v22, v226
    v_mul_f32 v153, v23, v240
    v_mul_f32 v166, v25, v226
    v_mul_f32 v167, v24, v240
    v_mul_f32 v20, v228, v228
    v_mul_f32 v21, v242, v242
    v_mul_f32 v22, v30, v20
    v_mul_f32 v23, v29, v20
    v_fma_f32 v24, v21, v30, v31
    v_fma_f32 v25, v21, v29, v31
    v_mul_f32 v154, v22, v228
    v_mul_f32 v155, v23, v242
    v_mul_f32 v168, v25, v228
    v_mul_f32 v169, v24, v242
    v_mul_f32 v20, v230, v230
    v_mul_f32 v21, v244, v244
    v_mul_f32 v22, v30, v20
    v_mul_f32 v23, v29, v20
    v_fma_f32 v24, v21, v30, v31
    v_fma_f32 v25, v21, v29, v31
    v_mul_f32 v156, v22, v230
    v_mul_f32 v157, v23, v244
    v_mul_f32 v170, v25, v230
    v_mul_f32 v171, v24, v244
    v_mul_f32 v20, v232, v232
    v_mul_f32 v21, v246, v246
    v_mul_f32 v22, v30, v20
    v_mul_f32 v23, v29, v20
    v_fma_f32 v24, v21, v30, v31
    v_fma_f32 v25, v21, v29, v31
    v_mul_f32 v158, v22, v232
    v_mul_f32 v159, v23, v246
    v_mul_f32 v172, v25, v232
    v_mul_f32 v173, v24, v246
    v_mul_f32 v20, v234, v234
    v_mul_f32 v21, v248, v248
    v_mul_f32 v22, v30, v20
    v_mul_f32 v23, v29, v20
    v_fma_f32 v24, v21, v30, v31
    v_fma_f32 v25, v21, v29, v31
    v_mul_f32 v160, v22, v234
    v_mul_f32 v161, v23, v248
    v_mul_f32 v174, v25, v234
    v_mul_f32 v175, v24, v248
    v_mul_f32 v20, v236, v236
    v_mul_f32 v21, v250, v250
    v_mul_f32 v22, v30, v20
    v_mul_f32 v23, v29, v20
    v_fma_f32 v24, v21, v30, v31
    v_fma_f32 v25, v21, v29, v31
    v_mul_f32 v162, v22, v236
    v_mul_f32 v163, v23, v250
    v_mul_f32 v176, v25, v236
    v_mul_f32 v177, v24, v250
    s_cmp_lg_u32 s3, 0
    s_cbranch_scc1 L_hop3_other
    s_waitcnt vmcnt(0)
    s_lshl_b32 s82, s2, 4
    s_add_u32 s82, s82, 7340032
    s_lshr_b32 s83, s2, 7
    s_lshl_b32 s83, s83, 11
    s_add_u32 s83, s83, 7340032
    s_and_b32 s93, s2, 7
    s_lshl_b32 s93, s93, 12
    s_add_u32 s83, s83, s93
    v_lshlrev_b32 v6, 12, v1
    v_lshlrev_b32 v7, 5, v1
    s_mov_b32 s93, 0
L_h2_poll:
    buffer_load_dwordx4 v[8:11], v74, s[64:67], s99 offen offset:0 sc1
    buffer_load_dwordx4 v[12:15], v74, s[64:67], s99 offen offset:1024 sc1
    buffer_load_dwordx4 v[16:19], v74, s[64:67], s99 offen offset:2048 sc1
    buffer_load_dwordx4 v[20:23], v74, s[64:67], s99 offen offset:3072 sc1
    s_waitcnt vmcnt(0)
    v_xor_b32 v8, s84, v8
    v_xor_b32 v9, s85, v9
    v_xor_b32 v10, s86, v10
    v_xor_b32 v11, s87, v11
    v_xor_b32 v12, s84, v12
    v_xor_b32 v13, s85, v13
    v_xor_b32 v14, s86, v14
    v_xor_b32 v15, s87, v15
    v_xor_b32 v16, s84, v16
    v_xor_b32 v17, s85, v17
    v_xor_b32 v18, s86, v18
    v_xor_b32 v19, s87, v19
    v_xor_b32 v20, s84, v20
    v_xor_b32 v21, s85, v21
    v_xor_b32 v22, s86, v22
    v_xor_b32 v23, s87, v23
    v_or3_b32 v24, v8, v9, v10
    v_or3_b32 v25, v12, v13, v14
    v_or3_b32 v26, v16, v17, v18
    v_or3_b32 v27, v20, v21, v22
    v_or3_b32 v24, v24, v11, v15
    v_or3_b32 v25, v25, v19, v23
    v_or3_b32 v24, v24, v26, v27
    v_or_b32 v24, v24, v25
    v_and_b32 v24, 0x3ff, v24
    v_cmp_ne_u32 vcc, 0, v24
    s_cbranch_vccz L_h2_ok
    s_mov_b64 exec, vcc
    s_sleep 1
    s_add_u32 s93, s93, 1
    s_cmp_lt_u32 s93, 20000
    s_cbranch_scc1 L_h2_poll
L_h2_ok:
    s_mov_b64 exec, -1
    v_pk_add_f32 v[8:9], v[8:9], v[12:13]
    v_pk_add_f32 v[10:11], v[10:11], v[14:15]
    v_pk_add_f32 v[16:17], v[16:17], v[20:21]
    v_pk_add_f32 v[18:19], v[18:19], v[22:23]
    v_pk_add_f32 v[8:9], v[8:9], v[16:17]
    v_pk_add_f32 v[10:11], v[10:11], v[18:19]
    s_nop 0
    v_permlane32_swap_b32 v8, v9
    v_permlane32_swap_b32 v10, v11
    v_add_f32 v8, v8, v9
    v_add_f32 v10, v10, v11
    s_nop 1
    v_permlane16_swap_b32 v8, v10
    v_add_f32 v8, v8, v10
    s_nop 1
    v_add_f32_dpp v8, v8, v8 row_ror:8 row_mask:0xf bank_mask:0xf
    s_nop 1
    v_add_f32_dpp v8, v8, v8 row_ror:4 row_mask:0xf bank_mask:0xf
    s_nop 1
    v_add_f32_dpp v8, v8, v8 row_ror:2 row_mask:0xf bank_mask:0xf
    v_cvt_pk_bf16_f32 v9, v8, v8
    v_and_b32 v8, s92, v9
    v_add_f32 v254, v252, v8
    v_cvt_pk_bf16_f32 v9, v254, v254
    v_and_b32 v254, s92, v9
    v_mul_f32 v9, v254, v254
    v_mov_b32 v8, v254
    s_nop 0
    v_add_f32_dpp v9, v9, v9 quad_perm:[1,0,3,2] row_mask:0xf bank_mask:0xf
    v_add_f32_dpp v8, v8, v8 quad_perm:[1,0,3,2] row_mask:0xf bank_mask:0xf
    v_mov_b32 v10, s76
    v_mov_b32 v11, s76
    v_permlane32_swap_b32 v8, v9
    v_add_f32 v8, v8, v9
    v_mov_b32 v9, v8
    s_nop 1
    v_permlane16_swap_b32 v8, v9
    v_add_f32 v8, v8, v9
    v_mov_b32 v9, v8
    s_nop 1
    v_permlane32_swap_b32 v8, v9
    s_mov_b32 exec_lo, 0xff
    s_mov_b32 exec_hi, 0x0
    buffer_store_dwordx4 v[8:11], v6, s[64:67], s82 offen sc1
    s_mov_b64 exec, -1
    s_mov_b32 s93, 0
    s_waitcnt vmcnt(0)
L_h3_poll:
    buffer_load_dwordx4 v[12:15], v7, s[64:67], s83 offen sc1
    buffer_load_dwordx4 v[16:19], v7, s[64:67], s83 offen offset:16 sc1
    s_waitcnt vmcnt(0)
    v_xor_b32 v20, s76, v14
    v_xor_b32 v21, s76, v18
    v_or_b32 v20, v20, v21
    v_cmp_ne_u32 vcc, 0, v20
    s_cbranch_vccz L_h3_ok
    s_mov_b64 exec, vcc
    s_sleep 1
    s_add_u32 s93, s93, 1
    s_cmp_lt_u32 s93, 20000
    s_cbranch_scc1 L_h3_poll
L_h3_ok:
    s_mov_b64 exec, -1
    v_add_f32 v12, v12, v16
    v_add_f32 v13, v13, v17
    s_nop 0
    v_add_f32_dpp v12, v12, v12 row_ror:8 row_mask:0xf bank_mask:0xf
    v_add_f32_dpp v13, v13, v13 row_ror:8 row_mask:0xf bank_mask:0xf
    s_nop 0
    v_add_f32_dpp v12, v12, v12 row_ror:4 row_mask:0xf bank_mask:0xf
    v_add_f32_dpp v13, v13, v13 row_ror:4 row_mask:0xf bank_mask:0xf
    s_nop 0
    v_add_f32_dpp v12, v12, v12 row_ror:2 row_mask:0xf bank_mask:0xf
    v_add_f32_dpp v13, v13, v13 row_ror:2 row_mask:0xf bank_mask:0xf
    s_nop 0
    v_add_f32_dpp v12, v12, v12 row_ror:1 row_mask:0xf bank_mask:0xf
    v_add_f32_dpp v13, v13, v13 row_ror:1 row_mask:0xf bank_mask:0xf
    v_mov_b32 v14, v12
    v_mov_b32 v15, v13
    s_nop 0
    v_permlane16_swap_b32 v12, v14
    v_permlane16_swap_b32 v13, v15
    v_add_f32 v12, v12, v14
    v_add_f32 v13, v13, v15
    v_mov_b32 v14, v12
    v_mov_b32 v15, v13
    s_nop 0
    v_permlane32_swap_b32 v12, v14
    v_permlane32_swap_b32 v13, v15
    v_add_f32 v12, v12, v14
    v_add_f32 v13, v13, v15
    v_mul_f32 v12, 0x3a800000, v12
    v_mul_f32 v13, 0x3a800000, v13
    v_fma_f32 v13, -v12, v12, v13
    v_mov_b32 v14, v12
    v_mov_b32 v15, v13
    v_cvt_pk_bf16_f32 v16, v14, v15
    v_lshlrev_b32 v14, 16, v16
    v_and_b32 v15, s92, v16
    v_add_f32 v15, 0x3727c5ac, v15
    v_cvt_pk_bf16_f32 v16, v15, v15
    v_and_b32 v15, s92, v16
    v_sqrt_f32 v15, v15
    s_nop 0
    v_cvt_pk_bf16_f32 v16, v15, v15
    v_and_b32 v15, s92, v16
    v_rcp_f32 v17, v15
    v_sub_f32 v18, v254, v14
    v_sub_f32 v12, v12, v14
    v_cvt_pk_bf16_f32 v16, v18, v18
    v_and_b32 v18, s92, v16
    v_mul_f32 v19, v18, v17
    v_mul_f32 v12, v12, v17
    v_mul_f32 v13, v13, v17
    v_fma_f32 v18, -v19, v15, v18
    v_mul_f32 v13, v13, v17
    v_fma_f32 v18, v18, v17, v19
    v_cvt_pk_bf16_f32 v16, v12, v13
    v_lshlrev_b32 v12, 16, v16
    v_and_b32 v13, s92, v16
    v_cvt_pk_bf16_f32 v16, v18, v18
    v_and_b32 v18, s92, v16
    v_add_f32 v13, 0x3727c5ac, v13
    v_cvt_pk_bf16_f32 v16, v13, v13
    v_and_b32 v13, s92, v16
    v_sqrt_f32 v13, v13
    v_sub_f32 v18, v18, v12
    v_cvt_pk_bf16_f32 v16, v13, v18
    v_lshlrev_b32 v13, 16, v16
    v_and_b32 v18, s92, v16
    v_rcp_f32 v17, v13
    v_lshlrev_b32 v4, 2, v1
    v_mul_f32 v19, v18, v17
    v_fma_f32 v18, -v19, v13, v18
    v_fma_f32 v18, v18, v17, v19
    v_cvt_pk_bf16_f32 v16, v18, v18
    v_and_b32 v18, s92, v16
    v_and_b32 v4, 1, v1
    v_lshrrev_b32 v5, 5, v1
    v_lshl_or_b32 v4, v5, 1, v4
    v_bfe_u32 v5, v1, 4, 1
    v_lshl_or_b32 v4, v5, 2, v4
    v_lshlrev_b32 v4, 2, v4
    s_mov_b32 exec_lo, 0x00030003
    s_mov_b32 exec_hi, 0x00030003
    ds_write_b32 v4, v18 offset:3968
    s_mov_b64 exec, -1
L_hop3_other:
    v_mov_b32 v4, 0
    v_mov_b32 v30, 0xbdd2d3e8
    v_mov_b32 v31, 0xc0135761
    s_waitcnt lgkmcnt(0)
    s_barrier
    ds_read_b128 v[32:35], v4 offset:3968
    ds_read_b128 v[36:39], v4 offset:3984
    s_waitcnt lgkmcnt(0)
    v_pk_fma_f32 v[96:97], v[150:151], v[32:33], v[150:151] op_sel:[0,0,1] op_sel_hi:[0,1,1]
    v_pk_fma_f32 v[98:99], v[152:153], v[32:33], v[152:153] op_sel:[0,0,1] op_sel_hi:[0,1,1]
    v_pk_fma_f32 v[100:101], v[154:155], v[32:33], v[154:155] op_sel:[0,0,1] op_sel_hi:[0,1,1]
    v_pk_fma_f32 v[102:103], v[156:157], v[32:33], v[156:157] op_sel:[0,0,1] op_sel_hi:[0,1,1]
    v_pk_fma_f32 v[104:105], v[158:159], v[32:33], v[158:159] op_sel:[0,0,1] op_sel_hi:[0,1,1]
    v_pk_fma_f32 v[106:107], v[160:161], v[32:33], v[160:161] op_sel:[0,0,1] op_sel_hi:[0,1,1]
    v_pk_fma_f32 v[108:109], v[162:163], v[32:33], v[162:163] op_sel:[0,0,1] op_sel_hi:[0,1,1]
    v_pk_fma_f32 v[96:97], v[96:97], v[32:33], v[164:165] op_sel_hi:[1,1,0]
    v_pk_fma_f32 v[98:99], v[98:99], v[32:33], v[166:167] op_sel_hi:[1,1,0]
    v_pk_fma_f32 v[100:101], v[100:101], v[32:33], v[168:169] op_sel_hi:[1,1,0]
    v_pk_fma_f32 v[102:103], v[102:103], v[32:33], v[170:171] op_sel_hi:[1,1,0]
    v_pk_fma_f32 v[104:105], v[104:105], v[32:33], v[172:173] op_sel_hi:[1,1,0]
    v_pk_fma_f32 v[106:107], v[106:107], v[32:33], v[174:175] op_sel_hi:[1,1,0]
    v_pk_fma_f32 v[108:109], v[108:109], v[32:33], v[176:177] op_sel_hi:[1,1,0]
    v_pk_fma_f32 v[80:81], v[224:225], v[32:33], v[238:239] op_sel:[1,0,1] op_sel_hi:[1,1,1]
    v_pk_fma_f32 v[82:83], v[226:227], v[32:33], v[240:241] op_sel:[1,0,1] op_sel_hi:[1,1,1]
    v_pk_fma_f32 v[84:85], v[228:229], v[32:33], v[242:243] op_sel:[1,0,1] op_sel_hi:[1,1,1]
    v_pk_fma_f32 v[86:87], v[230:231], v[32:33], v[244:245] op_sel:[1,0,1] op_sel_hi:[1,1,1]
    v_pk_fma_f32 v[88:89], v[232:233], v[32:33], v[246:247] op_sel:[1,0,1] op_sel_hi:[1,1,1]
    v_pk_fma_f32 v[90:91], v[234:235], v[32:33], v[248:249] op_sel:[1,0,1] op_sel_hi:[1,1,1]
    v_pk_fma_f32 v[92:93], v[236:237], v[32:33], v[250:251] op_sel:[1,0,1] op_sel_hi:[1,1,1]
    v_pk_fma_f32 v[96:97], v[96:97], v[32:33], v[164:165] op_sel:[0,0,1] op_sel_hi:[1,1,1]
    v_pk_fma_f32 v[98:99], v[98:99], v[32:33], v[166:167] op_sel:[0,0,1] op_sel_hi:[1,1,1]
    v_pk_fma_f32 v[100:101], v[100:101], v[32:33], v[168:169] op_sel:[0,0,1] op_sel_hi:[1,1,1]
    v_pk_fma_f32 v[102:103], v[102:103], v[32:33], v[170:171] op_sel:[0,0,1] op_sel_hi:[1,1,1]
    v_pk_fma_f32 v[104:105], v[104:105], v[32:33], v[172:173] op_sel:[0,0,1] op_sel_hi:[1,1,1]
    v_pk_fma_f32 v[106:107], v[106:107], v[32:33], v[174:175] op_sel:[0,0,1] op_sel_hi:[1,1,1]
    v_pk_fma_f32 v[108:109], v[108:109], v[32:33], v[176:177] op_sel:[0,0,1] op_sel_hi:[1,1,1]
    v_exp_f32 v96, v96
    v_pk_fma_f32 v[128:129], v[150:151], v[34:35], v[150:151] op_sel:[0,0,1] op_sel_hi:[0,1,1]
    v_exp_f32 v97, v97
    v_pk_fma_f32 v[130:131], v[152:153], v[34:35], v[152:153] op_sel:[0,0,1] op_sel_hi:[0,1,1]
    v_exp_f32 v98, v98
    v_pk_fma_f32 v[132:133], v[154:155], v[34:35], v[154:155] op_sel:[0,0,1] op_sel_hi:[0,1,1]
    v_exp_f32 v99, v99
    v_pk_fma_f32 v[134:135], v[156:157], v[34:35], v[156:157] op_sel:[0,0,1] op_sel_hi:[0,1,1]
    v_exp_f32 v100, v100
    v_pk_fma_f32 v[136:137], v[158:159], v[34:35], v[158:159] op_sel:[0,0,1] op_sel_hi:[0,1,1]
    v_exp_f32 v101, v101
    v_pk_fma_f32 v[138:139], v[160:161], v[34:35], v[160:161] op_sel:[0,0,1] op_sel_hi:[0,1,1]
    v_exp_f32 v102, v102
    v_pk_fma_f32 v[140:141], v[162:163], v[34:35], v[162:163] op_sel:[0,0,1] op_sel_hi:[0,1,1]
    v_exp_f32 v103, v103
    v_pk_fma_f32 v[128:129], v[128:129], v[34:35], v[164:165] op_sel_hi:[1,1,0]
    v_exp_f32 v104, v104
    v_pk_fma_f32 v[130:131], v[130:131], v[34:35], v[166:167] op_sel_hi:[1,1,0]
    v_exp_f32 v105, v105
    v_pk_fma_f32 v[132:133], v[132:133], v[34:35], v[168:169] op_sel_hi:[1,1,0]
    v_exp_f32 v106, v106
    v_pk_fma_f32 v[134:135], v[134:135], v[34:35], v[170:171] op_sel_hi:[1,1,0]
    v_exp_f32 v107, v107
    v_pk_fma_f32 v[136:137], v[136:137], v[34:35], v[172:173] op_sel_hi:[1,1,0]
    v_exp_f32 v108, v108
    v_pk_fma_f32 v[138:139], v[138:139], v[34:35], v[174:175] op_sel_hi:[1,1,0]
    v_exp_f32 v109, v109
    v_pk_fma_f32 v[140:141], v[140:141], v[34:35], v[176:177] op_sel_hi:[1,1,0]
    v_pk_add_f32 v[96:97], v[96:97], 1.0 op_sel_hi:[1,0]
    v_pk_add_f32 v[98:99], v[98:99], 1.0 op_sel_hi:[1,0]
    v_pk_add_f32 v[100:101], v[100:101], 1.0 op_sel_hi:[1,0]
    v_pk_add_f32 v[102:103], v[102:103], 1.0 op_sel_hi:[1,0]
    v_pk_add_f32 v[104:105], v[104:105], 1.0 op_sel_hi:[1,0]
    v_pk_add_f32 v[106:107], v[106:107], 1.0 op_sel_hi:[1,0]
    v_pk_add_f32 v[108:109], v[108:109], 1.0 op_sel_hi:[1,0]
    v_rcp_f32 v96, v96
    v_pk_fma_f32 v[112:113], v[224:225], v[34:35], v[238:239] op_sel:[1,0,1] op_sel_hi:[1,1,1]
    v_rcp_f32 v97, v97
    v_pk_fma_f32 v[114:115], v[226:227], v[34:35], v[240:241] op_sel:[1,0,1] op_sel_hi:[1,1,1]
    v_rcp_f32 v98, v98
    v_pk_fma_f32 v[116:117], v[228:229], v[34:35], v[242:243] op_sel:[1,0,1] op_sel_hi:[1,1,1]
    v_rcp_f32 v99, v99
    v_pk_fma_f32 v[118:119], v[230:231], v[34:35], v[244:245] op_sel:[1,0,1] op_sel_hi:[1,1,1]
    v_rcp_f32 v100, v100
    v_pk_fma_f32 v[120:121], v[232:233], v[34:35], v[246:247] op_sel:[1,0,1] op_sel_hi:[1,1,1]
    v_rcp_f32 v101, v101
    v_pk_fma_f32 v[122:123], v[234:235], v[34:35], v[248:249] op_sel:[1,0,1] op_sel_hi:[1,1,1]
    v_rcp_f32 v102, v102
    v_pk_fma_f32 v[124:125], v[236:237], v[34:35], v[250:251] op_sel:[1,0,1] op_sel_hi:[1,1,1]
    v_rcp_f32 v103, v103
    v_pk_fma_f32 v[128:129], v[128:129], v[34:35], v[164:165] op_sel:[0,0,1] op_sel_hi:[1,1,1]
    v_rcp_f32 v104, v104
    v_pk_fma_f32 v[130:131], v[130:131], v[34:35], v[166:167] op_sel:[0,0,1] op_sel_hi:[1,1,1]
    v_rcp_f32 v105, v105
    v_pk_fma_f32 v[132:133], v[132:133], v[34:35], v[168:169] op_sel:[0,0,1] op_sel_hi:[1,1,1]
    v_rcp_f32 v106, v106
    v_pk_fma_f32 v[134:135], v[134:135], v[34:35], v[170:171] op_sel:[0,0,1] op_sel_hi:[1,1,1]
    v_rcp_f32 v107, v107
    v_pk_fma_f32 v[136:137], v[136:137], v[34:35], v[172:173] op_sel:[0,0,1] op_sel_hi:[1,1,1]
    v_rcp_f32 v108, v108
    v_pk_fma_f32 v[138:139], v[138:139], v[34:35], v[174:175] op_sel:[0,0,1] op_sel_hi:[1,1,1]
    v_rcp_f32 v109, v109
    v_pk_fma_f32 v[140:141], v[140:141], v[34:35], v[176:177] op_sel:[0,0,1] op_sel_hi:[1,1,1]
    v_pk_mul_f32 v[40:41], v[80:81], v[96:97]
    v_pk_fma_f32 v[40:41], v[82:83], v[98:99], v[40:41]
    v_pk_fma_f32 v[40:41], v[84:85], v[100:101], v[40:41]
    v_pk_fma_f32 v[40:41], v[86:87], v[102:103], v[40:41]
    v_pk_fma_f32 v[40:41], v[88:89], v[104:105], v[40:41]
    v_pk_fma_f32 v[40:41], v[90:91], v[106:107], v[40:41]
    v_pk_fma_f32 v[40:41], v[92:93], v[108:109], v[40:41]
    v_exp_f32 v128, v128
    v_pk_fma_f32 v[96:97], v[150:151], v[36:37], v[150:151] op_sel:[0,0,1] op_sel_hi:[0,1,1]
    v_exp_f32 v129, v129
    v_pk_fma_f32 v[98:99], v[152:153], v[36:37], v[152:153] op_sel:[0,0,1] op_sel_hi:[0,1,1]
    v_exp_f32 v130, v130
    v_pk_fma_f32 v[100:101], v[154:155], v[36:37], v[154:155] op_sel:[0,0,1] op_sel_hi:[0,1,1]
    v_exp_f32 v131, v131
    v_pk_fma_f32 v[102:103], v[156:157], v[36:37], v[156:157] op_sel:[0,0,1] op_sel_hi:[0,1,1]
    v_exp_f32 v132, v132
    v_pk_fma_f32 v[104:105], v[158:159], v[36:37], v[158:159] op_sel:[0,0,1] op_sel_hi:[0,1,1]
    v_exp_f32 v133, v133
    v_pk_fma_f32 v[106:107], v[160:161], v[36:37], v[160:161] op_sel:[0,0,1] op_sel_hi:[0,1,1]
    v_exp_f32 v134, v134
    v_pk_fma_f32 v[108:109], v[162:163], v[36:37], v[162:163] op_sel:[0,0,1] op_sel_hi:[0,1,1]
    v_exp_f32 v135, v135
    v_pk_fma_f32 v[96:97], v[96:97], v[36:37], v[164:165] op_sel_hi:[1,1,0]
    v_exp_f32 v136, v136
    v_pk_fma_f32 v[98:99], v[98:99], v[36:37], v[166:167] op_sel_hi:[1,1,0]
    v_exp_f32 v137, v137
    v_pk_fma_f32 v[100:101], v[100:101], v[36:37], v[168:169] op_sel_hi:[1,1,0]
    v_exp_f32 v138, v138
    v_pk_fma_f32 v[102:103], v[102:103], v[36:37], v[170:171] op_sel_hi:[1,1,0]
    v_exp_f32 v139, v139
    v_pk_fma_f32 v[104:105], v[104:105], v[36:37], v[172:173] op_sel_hi:[1,1,0]
    v_exp_f32 v140, v140
    v_pk_fma_f32 v[106:107], v[106:107], v[36:37], v[174:175] op_sel_hi:[1,1,0]
    v_exp_f32 v141, v141
    v_pk_fma_f32 v[108:109], v[108:109], v[36:37], v[176:177] op_sel_hi:[1,1,0]
    v_pk_add_f32 v[128:129], v[128:129], 1.0 op_sel_hi:[1,0]
    v_pk_add_f32 v[130:131], v[130:131], 1.0 op_sel_hi:[1,0]
    v_pk_add_f32 v[132:133], v[132:133], 1.0 op_sel_hi:[1,0]
    v_pk_add_f32 v[134:135], v[134:135], 1.0 op_sel_hi:[1,0]
    v_pk_add_f32 v[136:137], v[136:137], 1.0 op_sel_hi:[1,0]
    v_pk_add_f32 v[138:139], v[138:139], 1.0 op_sel_hi:[1,0]
    v_pk_add_f32 v[140:141], v[140:141], 1.0 op_sel_hi:[1,0]
    v_rcp_f32 v128, v128
    v_pk_fma_f32 v[80:81], v[224:225], v[36:37], v[238:239] op_sel:[1,0,1] op_sel_hi:[1,1,1]
    v_rcp_f32 v129, v129
    v_pk_fma_f32 v[82:83], v[226:227], v[36:37], v[240:241] op_sel:[1,0,1] op_sel_hi:[1,1,1]
    v_rcp_f32 v130, v130
    v_pk_fma_f32 v[84:85], v[228:229], v[36:37], v[242:243] op_sel:[1,0,1] op_sel_hi:[1,1,1]
    v_rcp_f32 v131, v131
    v_pk_fma_f32 v[86:87], v[230:231], v[36:37], v[244:245] op_sel:[1,0,1] op_sel_hi:[1,1,1]
    v_rcp_f32 v132, v132
    v_pk_fma_f32 v[88:89], v[232:233], v[36:37], v[246:247] op_sel:[1,0,1] op_sel_hi:[1,1,1]
    v_rcp_f32 v133, v133
    v_pk_fma_f32 v[90:91], v[234:235], v[36:37], v[248:249] op_sel:[1,0,1] op_sel_hi:[1,1,1]
    v_rcp_f32 v134, v134
    v_pk_fma_f32 v[92:93], v[236:237], v[36:37], v[250:251] op_sel:[1,0,1] op_sel_hi:[1,1,1]
    v_rcp_f32 v135, v135
    v_pk_fma_f32 v[96:97], v[96:97], v[36:37], v[164:165] op_sel:[0,0,1] op_sel_hi:[1,1,1]
    v_rcp_f32 v136, v136
    v_pk_fma_f32 v[98:99], v[98:99], v[36:37], v[166:167] op_sel:[0,0,1] op_sel_hi:[1,1,1]
    v_rcp_f32 v137, v137
    v_pk_fma_f32 v[100:101], v[100:101], v[36:37], v[168:169] op_sel:[0,0,1] op_sel_hi:[1,1,1]
    v_rcp_f32 v138, v138
    v_pk_fma_f32 v[102:103], v[102:103], v[36:37], v[170:171] op_sel:[0,0,1] op_sel_hi:[1,1,1]
    v_rcp_f32 v139, v139
    v_pk_fma_f32 v[104:105], v[104:105], v[36:37], v[172:173] op_sel:[0,0,1] op_sel_hi:[1,1,1]
    v_rcp_f32 v140, v140
    v_pk_fma_f32 v[106:107], v[106:107], v[36:37], v[174:175] op_sel:[0,0,1] op_sel_hi:[1,1,1]
    v_rcp_f32 v141, v141
    v_pk_fma_f32 v[108:109], v[108:109], v[36:37], v[176:177] op_sel:[0,0,1] op_sel_hi:[1,1,1]
    v_pk_mul_f32 v[42:43], v[112:113], v[128:129]
    v_pk_fma_f32 v[42:43], v[114:115], v[130:131], v[42:43]
    v_pk_fma_f32 v[42:43], v[116:117], v[132:133], v[42:43]
    v_pk_fma_f32 v[42:43], v[118:119], v[134:135], v[42:43]
    v_pk_fma_f32 v[42:43], v[120:121], v[136:137], v[42:43]
    v_pk_fma_f32 v[42:43], v[122:123], v[138:139], v[42:43]
    v_pk_fma_f32 v[42:43], v[124:125], v[140:141], v[42:43]
    v_exp_f32 v96, v96
    v_pk_fma_f32 v[128:129], v[150:151], v[38:39], v[150:151] op_sel:[0,0,1] op_sel_hi:[0,1,1]
    v_exp_f32 v97, v97
    v_pk_fma_f32 v[130:131], v[152:153], v[38:39], v[152:153] op_sel:[0,0,1] op_sel_hi:[0,1,1]
    v_exp_f32 v98, v98
    v_pk_fma_f32 v[132:133], v[154:155], v[38:39], v[154:155] op_sel:[0,0,1] op_sel_hi:[0,1,1]
    v_exp_f32 v99, v99
    v_pk_fma_f32 v[134:135], v[156:157], v[38:39], v[156:157] op_sel:[0,0,1] op_sel_hi:[0,1,1]
    v_exp_f32 v100, v100
    v_pk_fma_f32 v[136:137], v[158:159], v[38:39], v[158:159] op_sel:[0,0,1] op_sel_hi:[0,1,1]
    v_exp_f32 v101, v101
    v_pk_fma_f32 v[138:139], v[160:161], v[38:39], v[160:161] op_sel:[0,0,1] op_sel_hi:[0,1,1]
    v_exp_f32 v102, v102
    v_pk_fma_f32 v[140:141], v[162:163], v[38:39], v[162:163] op_sel:[0,0,1] op_sel_hi:[0,1,1]
    v_exp_f32 v103, v103
    v_pk_fma_f32 v[128:129], v[128:129], v[38:39], v[164:165] op_sel_hi:[1,1,0]
    v_exp_f32 v104, v104
    v_pk_fma_f32 v[130:131], v[130:131], v[38:39], v[166:167] op_sel_hi:[1,1,0]
    v_exp_f32 v105, v105
    v_pk_fma_f32 v[132:133], v[132:133], v[38:39], v[168:169] op_sel_hi:[1,1,0]
    v_exp_f32 v106, v106
    v_pk_fma_f32 v[134:135], v[134:135], v[38:39], v[170:171] op_sel_hi:[1,1,0]
    v_exp_f32 v107, v107
    v_pk_fma_f32 v[136:137], v[136:137], v[38:39], v[172:173] op_sel_hi:[1,1,0]
    v_exp_f32 v108, v108
    v_pk_fma_f32 v[138:139], v[138:139], v[38:39], v[174:175] op_sel_hi:[1,1,0]
    v_exp_f32 v109, v109
    v_pk_fma_f32 v[140:141], v[140:141], v[38:39], v[176:177] op_sel_hi:[1,1,0]
    v_pk_add_f32 v[96:97], v[96:97], 1.0 op_sel_hi:[1,0]
    v_pk_add_f32 v[98:99], v[98:99], 1.0 op_sel_hi:[1,0]
    v_pk_add_f32 v[100:101], v[100:101], 1.0 op_sel_hi:[1,0]
    v_pk_add_f32 v[102:103], v[102:103], 1.0 op_sel_hi:[1,0]
    v_pk_add_f32 v[104:105], v[104:105], 1.0 op_sel_hi:[1,0]
    v_pk_add_f32 v[106:107], v[106:107], 1.0 op_sel_hi:[1,0]
    v_pk_add_f32 v[108:109], v[108:109], 1.0 op_sel_hi:[1,0]
    v_rcp_f32 v96, v96
    v_pk_fma_f32 v[112:113], v[224:225], v[38:39], v[238:239] op_sel:[1,0,1] op_sel_hi:[1,1,1]
    v_rcp_f32 v97, v97
    v_pk_fma_f32 v[114:115], v[226:227], v[38:39], v[240:241] op_sel:[1,0,1] op_sel_hi:[1,1,1]
    v_rcp_f32 v98, v98
    v_pk_fma_f32 v[116:117], v[228:229], v[38:39], v[242:243] op_sel:[1,0,1] op_sel_hi:[1,1,1]
    v_rcp_f32 v99, v99
    v_pk_fma_f32 v[118:119], v[230:231], v[38:39], v[244:245] op_sel:[1,0,1] op_sel_hi:[1,1,1]
    v_rcp_f32 v100, v100
    v_pk_fma_f32 v[120:121], v[232:233], v[38:39], v[246:247] op_sel:[1,0,1] op_sel_hi:[1,1,1]
    v_rcp_f32 v101, v101
    v_pk_fma_f32 v[122:123], v[234:235], v[38:39], v[248:249] op_sel:[1,0,1] op_sel_hi:[1,1,1]
    v_rcp_f32 v102, v102
    v_pk_fma_f32 v[124:125], v[236:237], v[38:39], v[250:251] op_sel:[1,0,1] op_sel_hi:[1,1,1]
    v_rcp_f32 v103, v103
    v_pk_fma_f32 v[128:129], v[128:129], v[38:39], v[164:165] op_sel:[0,0,1] op_sel_hi:[1,1,1]
    v_rcp_f32 v104, v104
    v_pk_fma_f32 v[130:131], v[130:131], v[38:39], v[166:167] op_sel:[0,0,1] op_sel_hi:[1,1,1]
    v_rcp_f32 v105, v105
    v_pk_fma_f32 v[132:133], v[132:133], v[38:39], v[168:169] op_sel:[0,0,1] op_sel_hi:[1,1,1]
    v_rcp_f32 v106, v106
    v_pk_fma_f32 v[134:135], v[134:135], v[38:39], v[170:171] op_sel:[0,0,1] op_sel_hi:[1,1,1]
    v_rcp_f32 v107, v107
    v_pk_fma_f32 v[136:137], v[136:137], v[38:39], v[172:173] op_sel:[0,0,1] op_sel_hi:[1,1,1]
    v_rcp_f32 v108, v108
    v_pk_fma_f32 v[138:139], v[138:139], v[38:39], v[174:175] op_sel:[0,0,1] op_sel_hi:[1,1,1]
    v_rcp_f32 v109, v109
    v_pk_fma_f32 v[140:141], v[140:141], v[38:39], v[176:177] op_sel:[0,0,1] op_sel_hi:[1,1,1]
    v_pk_mul_f32 v[44:45], v[80:81], v[96:97]
    v_pk_fma_f32 v[44:45], v[82:83], v[98:99], v[44:45]
    v_pk_fma_f32 v[44:45], v[84:85], v[100:101], v[44:45]
    v_pk_fma_f32 v[44:45], v[86:87], v[102:103], v[44:45]
    v_pk_fma_f32 v[44:45], v[88:89], v[104:105], v[44:45]
    v_pk_fma_f32 v[44:45], v[90:91], v[106:107], v[44:45]
    v_pk_fma_f32 v[44:45], v[92:93], v[108:109], v[44:45]
    v_exp_f32 v128, v128
    v_exp_f32 v129, v129
    v_exp_f32 v130, v130
    v_exp_f32 v131, v131
    v_exp_f32 v132, v132
    v_exp_f32 v133, v133
    v_exp_f32 v134, v134
    v_exp_f32 v135, v135
    v_exp_f32 v136, v136
    v_exp_f32 v137, v137
    v_exp_f32 v138, v138
    v_exp_f32 v139, v139
    v_exp_f32 v140, v140
    v_exp_f32 v141, v141
    v_pk_add_f32 v[128:129], v[128:129], 1.0 op_sel_hi:[1,0]
    v_pk_add_f32 v[130:131], v[130:131], 1.0 op_sel_hi:[1,0]
    v_pk_add_f32 v[132:133], v[132:133], 1.0 op_sel_hi:[1,0]
    v_pk_add_f32 v[134:135], v[134:135], 1.0 op_sel_hi:[1,0]
    v_pk_add_f32 v[136:137], v[136:137], 1.0 op_sel_hi:[1,0]
    v_pk_add_f32 v[138:139], v[138:139], 1.0 op_sel_hi:[1,0]
    v_pk_add_f32 v[140:141], v[140:141], 1.0 op_sel_hi:[1,0]
    v_rcp_f32 v128, v128
    v_rcp_f32 v129, v129
    v_rcp_f32 v130, v130
    v_rcp_f32 v131, v131
    v_rcp_f32 v132, v132
    v_rcp_f32 v133, v133
    v_rcp_f32 v134, v134
    v_rcp_f32 v135, v135
    v_rcp_f32 v136, v136
    v_rcp_f32 v137, v137
    v_rcp_f32 v138, v138
    v_rcp_f32 v139, v139
    v_rcp_f32 v140, v140
    v_rcp_f32 v141, v141
    v_pk_mul_f32 v[46:47], v[112:113], v[128:129]
    v_pk_fma_f32 v[46:47], v[114:115], v[130:131], v[46:47]
    v_pk_fma_f32 v[46:47], v[116:117], v[132:133], v[46:47]
    v_pk_fma_f32 v[46:47], v[118:119], v[134:135], v[46:47]
    v_pk_fma_f32 v[46:47], v[120:121], v[136:137], v[46:47]
    v_pk_fma_f32 v[46:47], v[122:123], v[138:139], v[46:47]
    v_pk_fma_f32 v[46:47], v[124:125], v[140:141], v[46:47]
    v_permlane32_swap_b32 v40, v44
    v_permlane32_swap_b32 v41, v45
    v_permlane32_swap_b32 v42, v46
    v_permlane32_swap_b32 v43, v47
    v_add_f32 v40, v40, v44
    v_add_f32 v41, v41, v45
    v_add_f32 v42, v42, v46
    v_add_f32 v43, v43, v47
    s_nop 0
    v_permlane16_swap_b32 v40, v42
    v_permlane16_swap_b32 v41, v43
    v_add_f32 v40, v40, v42
    v_add_f32 v41, v41, v43
    v_and_b32 v4, 32, v1
    v_lshlrev_b32 v4, 2, v4
    v_and_b32 v5, 16, v1
    v_lshlrev_b32 v5, 2, v5
    s_lshl_b32 s82, s3, 2
    v_add3_u32 v4, v4, v5, s82
    v_add_f32_dpp v40, v40, v40 row_ror:8 row_mask:0xf bank_mask:0xf
    v_add_f32_dpp v41, v41, v41 row_ror:8 row_mask:0xf bank_mask:0xf
    s_nop 0
    v_add_f32_dpp v40, v40, v40 row_ror:4 row_mask:0xf bank_mask:0xf
    v_add_f32_dpp v41, v41, v41 row_ror:4 row_mask:0xf bank_mask:0xf
    s_nop 0
    v_add_f32_dpp v40, v40, v40 row_ror:2 row_mask:0xf bank_mask:0xf
    v_add_f32_dpp v41, v41, v41 row_ror:2 row_mask:0xf bank_mask:0xf
    s_nop 0
    v_add_f32_dpp v40, v40, v40 row_ror:1 row_mask:0xf bank_mask:0xf
    v_add_f32_dpp v41, v41, v41 row_ror:1 row_mask:0xf bank_mask:0xf
    s_mov_b32 exec_lo, 0x00010001
    s_mov_b32 exec_hi, 0x00010001
    ds_write_b32 v4, v40 offset:4608
    ds_write_b32 v4, v41 offset:4640
    s_mov_b64 exec, -1
    v_and_b32 v5, 1, v1
    v_lshrrev_b32 v6, 5, v1
    v_lshl_or_b32 v5, v6, 1, v5
    v_bfe_u32 v6, v1, 4, 1
    v_lshl_or_b32 v5, v6, 2, v5
    v_lshlrev_b32 v5, 5, v5
    v_and_b32 v6, 1, v1
    v_lshlrev_b32 v6, 1, v6
    v_and_b32 v7, 32, v1
    v_lshrrev_b32 v7, 2, v7
    v_or_b32 v6, v6, v7
    v_and_b32 v7, 16, v1
    v_or_b32 v6, v6, v7
    s_waitcnt lgkmcnt(0)
    s_barrier
    s_cmp_lg_u32 s3, 0
    s_cbranch_scc1 L_fin
    ds_read_b128 v[8:11], v5 offset:4608
    ds_read_b128 v[12:15], v5 offset:4624
    s_waitcnt lgkmcnt(0)
    v_pk_add_f32 v[8:9], v[8:9], v[10:11]
    v_pk_add_f32 v[12:13], v[12:13], v[14:15]
    v_pk_add_f32 v[8:9], v[8:9], v[12:13]
    v_add_f32 v8, v8, v9
    v_cvt_pk_bf16_f32 v9, v8, v8
    v_and_b32 v8, s92, v9
    v_add_f32 v8, v8, v253
    v_cvt_pk_bf16_f32 v9, v8, v8
    v_and_b32 v8, s92, v9
    v_add_f32 v8, v8, v254
    v_cvt_pk_bf16_f32 v8, v8, v8
    s_mov_b32 exec_lo, 0x00030003
    s_mov_b32 exec_hi, 0x00030003
    buffer_store_short v8, v6, s[68:71], s77 offen
    s_mov_b64 exec, -1
    s_cmp_lg_u32 s2, 0
    s_cbranch_scc1 L_fin
    v_mov_b32 v4, 0
    v_mov_b32 v5, s76
    s_mov_b64 exec, 1
    buffer_store_dword v5, v4, s[64:67], 0 offen sc1
    s_mov_b64 exec, -1
L_fin:
    s_waitcnt vmcnt(0) lgkmcnt(0)
    s_branch L_end
L_mlretry:
    s_waitcnt vmcnt(0)
L_mlr_loop:
    s_sleep 2
    buffer_load_dwordx4 v[80:83], v75, s[64:67], s79 offen offset:0 sc1
    buffer_load_dwordx4 v[84:87], v75, s[64:67], s79 offen offset:128 sc1
    buffer_load_dwordx4 v[88:91], v75, s[64:67], s79 offen offset:256 sc1
    buffer_load_dwordx4 v[92:95], v75, s[64:67], s79 offen offset:384 sc1
    s_waitcnt vmcnt(0)
    v_xor_b32 v100, s76, v82
    v_xor_b32 v101, s76, v86
    v_xor_b32 v102, s76, v90
    v_xor_b32 v103, s76, v94
    v_or3_b32 v100, v100, v101, v102
    v_or_b32 v100, v100, v103
    v_cmp_ne_u32 vcc, 0, v100
    s_cbranch_vccz L_mlr_out
    s_add_u32 s93, s93, 1
    s_cmp_lt_u32 s93, 20000
    s_nop 1
    s_cbranch_scc1 L_mlr_loop
L_mlr_out:
    s_nop 4
    s_branch L_mlok
L_qretry:
    s_mov_b32 s93, 0
L_qr_loop:
    s_sleep 2
    buffer_load_dwordx4 v[8:11], v4, s[64:67], s95 offen sc1
    buffer_load_dwordx4 v[12:15], v5, s[64:67], s95 offen sc1
    s_waitcnt vmcnt(0)
    v_and_b32 v20, 15, s84
    v_and_b32 v21, 15, s85
    v_and_b32 v22, 15, s86
    v_and_b32 v23, 15, s87
    v_xor_b32 v8, v20, v8
    v_xor_b32 v9, v21, v9
    v_xor_b32 v10, v22, v10
    v_xor_b32 v11, v23, v11
    v_xor_b32 v12, v20, v12
    v_xor_b32 v13, v21, v13
    v_xor_b32 v14, v22, v14
    v_xor_b32 v15, v23, v15
    v_or3_b32 v16, v8, v9, v10
    v_or3_b32 v17, v11, v12, v13
    v_or3_b32 v16, v16, v14, v15
    v_or_b32 v16, v16, v17
    v_and_b32 v16, 15, v16
    v_cmp_ne_u32 vcc, 0, v16
    s_cbranch_vccz L_qr_out
    s_add_u32 s93, s93, 1
    s_cmp_lt_u32 s93, 20000
    s_nop 1
    s_cbranch_scc1 L_qr_loop
L_qr_out:
    s_nop 4
    s_branch L_qok
L_end:
    s_endpgm

.section .rodata,"a"
.p2align 6
.amdhsa_kernel sequential_preLN__gqa_block_cached__mixer_token_mlp__decode_kernel
  .amdhsa_next_free_vgpr 256
  .amdhsa_next_free_sgpr 102
  .amdhsa_accum_offset 256
  .amdhsa_group_segment_fixed_size 0
  .amdhsa_kernarg_size 104
  .amdhsa_user_sgpr_count 2
  .amdhsa_user_sgpr_kernarg_segment_ptr 1
  .amdhsa_system_sgpr_workgroup_id_x 1
.end_amdhsa_kernel
```
